```python
import torch

def _softmax(x, axis=-1):
    return torch.softmax(x, dim=axis)
def _gelu(x):
    return torch.nn.functional.gelu(x, approximate="tanh")
def _silu(x):
    return torch.nn.functional.silu(x)
def _sigmoid(x):
    return torch.sigmoid(x)
def _layernorm(x, axis=-1, eps=1e-5):
    m = x.mean(dim=axis, keepdim=True)
    v = x.var(dim=axis, keepdim=True, unbiased=False)
    return (x - m) / torch.sqrt(v + eps)
def _scatter_add(tgt, idx, src, axis=0):
    return tgt.clone().index_add_(axis, idx, src)
def _segment_sum(src, seg, n):
    out = torch.zeros((n,) + src.shape[1:], dtype=src.dtype)
    return out.index_add_(0, seg, src)
def _pad(x, pw):
    flat = tuple(v for pair in reversed(pw) for v in pair)
    return torch.nn.functional.pad(x, flat)

kernel_name = 'gated_mix__grouped_kv_mqa__ssm_conv_s4d__prompt'

def setup_inputs():

    _w = (lambda a: (lambda t: t.to(torch.bfloat16) if t.is_floating_point() else t)(torch.as_tensor(a)))
    def _A_setup():
        B, S, D, H = 1, 2048, 512, 32
        Dh = D // H
        return {
            "x": _w((lambda *s: torch.randn(*s, dtype=torch.bfloat16) * 0.05)(B, S, D)),
            "wq": _w((lambda *s: torch.randn(*s, dtype=torch.bfloat16) * 0.8)(D, H * Dh)),
            "wk": _w((lambda *s: torch.randn(*s, dtype=torch.bfloat16) * 0.8)(D, Dh)),
            "wv": _w((lambda *s: torch.randn(*s, dtype=torch.bfloat16) * 0.05)(D, Dh)),
            "wo": _w((lambda *s: torch.randn(*s, dtype=torch.bfloat16) * 0.05)(H * Dh, D)),
        }
    _A_in = _A_setup()

    def _B_setup():
        Bsz, L, D, N = 1, 2048, 512, 128
        return {
            "u": _w((lambda *s: torch.randn(*s, dtype=torch.bfloat16) * 0.05)(Bsz, L, D)),
            "log_A_real": _w((lambda *s: torch.randn(*s, dtype=torch.bfloat16) * 6.4)(D, N) * 0.5),
            "A_imag": _w((lambda *s: torch.randn(*s, dtype=torch.bfloat16) * 0.05)(D, N) * 3.14),
            "C_real": _w((lambda *s: torch.randn(*s, dtype=torch.bfloat16) * 0.05)(D, N) / N ** 0.5),
            "C_imag": _w((lambda *s: torch.randn(*s, dtype=torch.bfloat16) * 0.05)(D, N) / N ** 0.5),
            "log_dt": _w((lambda *s: torch.randn(*s, dtype=torch.bfloat16) * 0.05)(D) * 0.5 - 4.0),
            "D_skip": _w((lambda *s: torch.randn(*s, dtype=torch.bfloat16) * 0.05)(D)),
        }
    _B_in = _B_setup()

    return {
        "A_x": _A_in["x"],
        "A_wq": _A_in["wq"],
        "A_wk": _A_in["wk"],
        "A_wv": _A_in["wv"],
        "A_wo": _A_in["wo"],
        "B_u": _B_in["u"],
        "B_log_A_real": _B_in["log_A_real"],
        "B_A_imag": _B_in["A_imag"],
        "B_C_real": _B_in["C_real"],
        "B_C_imag": _B_in["C_imag"],
        "B_log_dt": _B_in["log_dt"],
        "B_D_skip": _B_in["D_skip"],
        "gate_w": _w((lambda *s: torch.randn(*s, dtype=torch.bfloat16) * 0.05)(512) * 16.0),
    }

def reference(A_x, A_wq, A_wk, A_wv, A_wo, B_u, B_log_A_real, B_A_imag, B_C_real, B_C_imag, B_log_dt, B_D_skip, gate_w):
    def _A_ref(x, wq, wk, wv, wo):
        B, S, D = x.shape
        H = 32
        Dh = D // H
        q = (lambda x, *d: x.permute(*d))((x @ wq).reshape(B, S, H, Dh), 0, 2, 1, 3)
        k = x @ wk
        v = x @ wv
        scores = torch.einsum("bhqd,bkd->bhqk", q, k) * (Dh ** -0.5)
        p = _softmax(scores, axis=-1)
        o = torch.einsum("bhqk,bkd->bhqd", p, v)
        return (lambda x, *d: x.permute(*d))(o, 0, 2, 1, 3).reshape(B, S, H * Dh) @ wo

    def _B_ref(u, log_A_real, A_imag, C_real, C_imag, log_dt, D_skip):
        L = u.shape[1]
        dt = torch.exp(log_dt)
        A = -torch.exp(log_A_real) + 1j * A_imag
        C = (C_real + 1j * C_imag) * dt[:, None]
        pos = (lambda x, dt: x.to(dt))(torch.arange(L), log_dt.dtype)
        P = torch.exp((A * dt[:, None])[:, :, None] * pos[None, None, :])
        K = 2.0 * torch.einsum("dn,dnl->dl", C, P).real
        L2 = 2 * L
        u_t = (lambda x, *d: x.permute(*d))(u, 0, 2, 1)
        Kf = (lambda x, *a, **k: torch.fft.rfft(x.float(), *a, **k))(K, L2)
        Uf = (lambda x, *a, **k: torch.fft.rfft(x.float(), *a, **k))(u_t, L2)
        y = (lambda x, *a, **k: torch.fft.irfft(x, *a, **k).to(torch.bfloat16))(Uf * Kf[None, :, :], L2)[:, :, :L]
        y = (lambda x, *d: x.permute(*d))(y, 0, 2, 1)
        return y + u * D_skip[None, None, :]

    x = A_x
    g = _sigmoid((x * gate_w).sum(-1, keepdims=True))
    a = _A_ref(x, A_wq, A_wk, A_wv, A_wo)
    b = _B_ref(x, B_log_A_real, B_A_imag, B_C_real, B_C_imag, B_log_dt, B_D_skip)
    return g * a + (1 - g) * b
```

```asm
; @launch grid=(256,1,1) block=(768,1,1) lds=163840
.amdgcn_target "amdgcn-amd-amdhsa--gfx950"
.text
.globl gated_mix__grouped_kv_mqa__ssm_conv_s4d__prompt_kernel
.p2align 8
.type gated_mix__grouped_kv_mqa__ssm_conv_s4d__prompt_kernel,@function
gated_mix__grouped_kv_mqa__ssm_conv_s4d__prompt_kernel:
    s_cmp_ge_u32 s2, 256
    s_cbranch_scc1 L_end
    s_load_dwordx16 s[4:19], s[0:1], 0
    s_load_dwordx16 s[20:35], s[0:1], 64
    v_and_b32 v1, 63, v0
    v_lshrrev_b32 v6, 6, v0
    v_lshlrev_b32 v2, 4, v1
    v_readfirstlane_b32 s68, v6
    v_mov_b32 v3, 162560
    v_lshl_add_u32 v6, v1, 2, v3
    v_mov_b32 v7, 0
    ds_write_b32 v6, v7
    v_mov_b32 v166, 1
    s_mov_b32 s83, 0x100000
    s_and_b32 s74, s2, 7
    s_lshr_b32 s75, s2, 3
    s_lshr_b32 s76, s75, 3
    s_lshl_b32 s69, s74, 2
    s_add_u32 s69, s69, s76
    s_and_b32 s70, s75, 7
    s_lshl_b32 s71, s74, 6
    s_lshl_b32 s75, s75, 1
    s_add_u32 s71, s71, s75
    s_lshr_b32 s98, s70, 2
    s_mov_b32 s101, s74
    v_and_b32 v4, 15, v1
    v_lshrrev_b32 v5, 4, v1
    s_bfe_u32 s74, s68, 0x10001
    s_add_u32 s74, s71, s74
    s_lshl_b32 s74, s74, 8
    s_and_b32 s75, s68, 1
    s_lshl_b32 s75, s75, 6
    s_add_u32 s74, s74, s75
    s_lshr_b32 s75, s68, 3
    s_lshl_b32 s75, s75, 7
    s_add_u32 s74, s74, s75
    v_and_b32 v6, 31, v1
    v_lshlrev_b32 v6, 1, v6
    v_add_u32 v6, s74, v6
    s_cmp_lt_u32 s68, 4
    s_waitcnt lgkmcnt(0)
    s_cbranch_scc1 L_nopar
    global_load_ushort v14, v6, s[16:17]
    global_load_ushort v15, v6, s[18:19]
    global_load_ushort v16, v6, s[20:21]
    global_load_ushort v17, v6, s[22:23]
L_nopar:
    s_barrier
    s_mov_b32 s36, s4
    s_and_b32 s37, s5, 0xffff
    s_mov_b32 s38, 2097152
    s_mov_b32 s39, 0x00020000
    s_mov_b32 s48, s34
    s_and_b32 s49, s35, 0xffff
    s_mov_b32 s50, 9437184
    s_mov_b32 s51, 0x00020000
    s_mov_b32 s40, s6
    s_and_b32 s41, s7, 0xffff
    s_mov_b32 s42, 524288
    s_mov_b32 s43, 0x00020000
    s_mov_b32 s56, s28
    s_and_b32 s57, s29, 0xffff
    s_mov_b32 s58, 1024
    s_mov_b32 s59, 0x00020000
    s_bitcmp1_b32 s70, 0
    s_cselect_b32 s44, s10, s8
    s_cselect_b32 s45, s11, s9
    s_and_b32 s45, s45, 0xffff
    s_mov_b32 s46, 16384
    s_mov_b32 s47, 0x00020000
    s_lshl_b32 s89, s71, 1
    s_load_dword s72, s[24:25], s89
    s_load_dword s73, s[26:27], s89
    s_cmp_ge_u32 s68, 4
    s_cbranch_scc1 L_main
    s_setprio 3
    v_mov_b32 v11, 327680
    buffer_load_dword v164, v11, s[48:51], 0 offen sc1
    s_cmp_eq_u32 s68, 1
    s_cbranch_scc1 L_h1
    s_cmp_ge_u32 s68, 2
    s_cbranch_scc1 L_h23
    s_lshl_b32 s74, s69, 16
    s_lshr_b32 s75, s70, 1
    s_lshl_b32 s75, s75, 14
    s_add_u32 s74, s74, s75
    s_and_b32 s75, s75, 0x4000
    s_add_u32 s75, s75, 16384
    v_lshlrev_b32 v152, 10, v4
    v_xor_b32 v7, v5, v4
    v_lshl_add_u32 v152, v7, 4, v152
    v_add_u32 v152, s75, v152
    s_mov_b32 s81, 0
L_xpk:
    s_mov_b32 m0, s75
    v_xor_b32 v6, 0, v2
    buffer_load_dwordx4 v6, s[36:39], s74 offen lds
    s_add_u32 s75, s75, 1024
    s_add_u32 s74, s74, 1024
    s_mov_b32 m0, s75
    v_xor_b32 v6, 16, v2
    buffer_load_dwordx4 v6, s[36:39], s74 offen lds
    s_add_u32 s75, s75, 1024
    s_add_u32 s74, s74, 1024
    s_mov_b32 m0, s75
    v_xor_b32 v6, 32, v2
    buffer_load_dwordx4 v6, s[36:39], s74 offen lds
    s_add_u32 s75, s75, 1024
    s_add_u32 s74, s74, 1024
    s_mov_b32 m0, s75
    v_xor_b32 v6, 48, v2
    buffer_load_dwordx4 v6, s[36:39], s74 offen lds
    s_add_u32 s75, s75, 1024
    s_add_u32 s74, s74, 1024
    s_mov_b32 m0, s75
    v_xor_b32 v6, 64, v2
    buffer_load_dwordx4 v6, s[36:39], s74 offen lds
    s_add_u32 s75, s75, 1024
    s_add_u32 s74, s74, 1024
    s_mov_b32 m0, s75
    v_xor_b32 v6, 80, v2
    buffer_load_dwordx4 v6, s[36:39], s74 offen lds
    s_add_u32 s75, s75, 1024
    s_add_u32 s74, s74, 1024
    s_mov_b32 m0, s75
    v_xor_b32 v6, 96, v2
    buffer_load_dwordx4 v6, s[36:39], s74 offen lds
    s_add_u32 s75, s75, 1024
    s_add_u32 s74, s74, 1024
    s_mov_b32 m0, s75
    v_xor_b32 v6, 112, v2
    buffer_load_dwordx4 v6, s[36:39], s74 offen lds
    s_add_u32 s75, s75, 1024
    s_add_u32 s74, s74, 1024
    s_mov_b32 m0, s75
    v_xor_b32 v6, 128, v2
    buffer_load_dwordx4 v6, s[36:39], s74 offen lds
    s_add_u32 s75, s75, 1024
    s_add_u32 s74, s74, 1024
    s_mov_b32 m0, s75
    v_xor_b32 v6, 144, v2
    buffer_load_dwordx4 v6, s[36:39], s74 offen lds
    s_add_u32 s75, s75, 1024
    s_add_u32 s74, s74, 1024
    s_mov_b32 m0, s75
    v_xor_b32 v6, 160, v2
    buffer_load_dwordx4 v6, s[36:39], s74 offen lds
    s_add_u32 s75, s75, 1024
    s_add_u32 s74, s74, 1024
    s_mov_b32 m0, s75
    v_xor_b32 v6, 176, v2
    buffer_load_dwordx4 v6, s[36:39], s74 offen lds
    s_add_u32 s75, s75, 1024
    s_add_u32 s74, s74, 1024
    s_mov_b32 m0, s75
    v_xor_b32 v6, 192, v2
    buffer_load_dwordx4 v6, s[36:39], s74 offen lds
    s_add_u32 s75, s75, 1024
    s_add_u32 s74, s74, 1024
    s_mov_b32 m0, s75
    v_xor_b32 v6, 208, v2
    buffer_load_dwordx4 v6, s[36:39], s74 offen lds
    s_add_u32 s75, s75, 1024
    s_add_u32 s74, s74, 1024
    s_mov_b32 m0, s75
    v_xor_b32 v6, 224, v2
    buffer_load_dwordx4 v6, s[36:39], s74 offen lds
    s_add_u32 s75, s75, 1024
    s_add_u32 s74, s74, 1024
    s_mov_b32 m0, s75
    v_xor_b32 v6, 240, v2
    buffer_load_dwordx4 v6, s[36:39], s74 offen lds
    s_add_u32 s75, s75, 1024
    s_add_u32 s74, s74, 1024
    s_mov_b32 m0, 162816
    s_mov_b32 s75, 0
    buffer_load_dwordx4 v2, s[56:59], 0 offen lds
    v_xor_b32 v153, 64, v152
    v_xor_b32 v154, 0x80, v152
    v_xor_b32 v155, 0xc0, v152
    s_mov_b32 m0, 0
    s_nop 0
    buffer_load_dwordx4 v2, s[44:47], s75 offen offset:0 lds
    buffer_load_dwordx4 v2, s[44:47], s75 offen offset:1024 lds
    buffer_load_dwordx4 v2, s[44:47], s75 offen offset:2048 lds
    buffer_load_dwordx4 v2, s[44:47], s75 offen offset:3072 lds
    s_add_u32 s75, s75, 4096
    s_mov_b32 m0, 4096
    s_nop 0
    buffer_load_dwordx4 v2, s[44:47], s75 offen offset:0 lds
    buffer_load_dwordx4 v2, s[44:47], s75 offen offset:1024 lds
    buffer_load_dwordx4 v2, s[44:47], s75 offen offset:2048 lds
    buffer_load_dwordx4 v2, s[44:47], s75 offen offset:3072 lds
    s_add_u32 s75, s75, 4096
    s_mov_b32 m0, 8192
    s_nop 0
    buffer_load_dwordx4 v2, s[44:47], s75 offen offset:0 lds
    buffer_load_dwordx4 v2, s[44:47], s75 offen offset:1024 lds
    buffer_load_dwordx4 v2, s[44:47], s75 offen offset:2048 lds
    buffer_load_dwordx4 v2, s[44:47], s75 offen offset:3072 lds
    s_add_u32 s75, s75, 4096
    s_mov_b32 m0, 12288
    s_nop 0
    buffer_load_dwordx4 v2, s[44:47], s75 offen offset:0 lds
    buffer_load_dwordx4 v2, s[44:47], s75 offen offset:1024 lds
    buffer_load_dwordx4 v2, s[44:47], s75 offen offset:2048 lds
    buffer_load_dwordx4 v2, s[44:47], s75 offen offset:3072 lds
    s_add_u32 s75, s75, 4096
    v_lshlrev_b32 v6, 8, v5
    v_lshl_add_u32 v6, v4, 3, v6
    v_add_u32 v6, 0, v6
    v_lshlrev_b32 v7, 4, v5
    v_add_u32 v7, 162816, v7
    s_lshl_b32 s74, s69, 2
    s_lshr_b32 s75, s70, 1
    s_add_u32 s74, s74, s75
    s_lshr_b32 s75, s74, 1
    s_lshl_b32 s75, s75, 11
    s_and_b32 s76, s74, 1
    s_lshl_b32 s76, s76, 8
    s_add_u32 s75, s75, s76
    s_and_b32 s76, s70, 1
    s_lshl_b32 s76, s76, 10
    s_add_u32 s75, s75, s76
    s_lshl_b32 s74, s74, 6
    s_add_u32 s74, s74, 131072
    v_and_b32 v8, 1, v5
    v_lshrrev_b32 v9, 1, v5
    s_add_u32 s76, s75, 524288
    s_mov_b32 s77, 524288
    s_mul_i32 s89, s101, 4352
    s_lshr_b32 s90, s2, 3
    s_lshl_b32 s90, s90, 2
    s_add_u32 s89, s89, s90
    s_add_u32 s89, s89, 196608
    v_mov_b32 v11, s89
    s_waitcnt vmcnt(33) lgkmcnt(0)
    v_readfirstlane_b32 s99, v164
    s_nop 0
    s_mul_i32 s99, s99, 0x9e3779b1
    s_add_u32 s99, s99, 0x7f4a7c15
    s_getreg_b32 s89, hwreg(HW_REG_XCC_ID, 0, 4)
    s_xor_b32 s89, s89, s99
    v_mov_b32 v12, s89
    s_waitcnt vmcnt(17)
    s_mov_b64 exec, 1
    ds_add_u32 v3, v166 offset:4
    s_mov_b64 exec, -1
    ds_read_b128 v[16:19], v152 offset:0
    ds_read_b128 v[20:23], v153 offset:0
    ds_read_b128 v[24:27], v154 offset:0
    ds_read_b128 v[28:31], v155 offset:0
    ds_read_b128 v[32:35], v152 offset:256
    ds_read_b128 v[36:39], v153 offset:256
    ds_read_b128 v[40:43], v154 offset:256
    ds_read_b128 v[44:47], v155 offset:256
    ds_read_b128 v[48:51], v152 offset:512
    ds_read_b128 v[52:55], v153 offset:512
    ds_read_b128 v[56:59], v154 offset:512
    ds_read_b128 v[60:63], v155 offset:512
    ds_read_b128 v[64:67], v152 offset:768
    ds_read_b128 v[68:71], v153 offset:768
    ds_read_b128 v[72:75], v154 offset:768
    ds_read_b128 v[76:79], v155 offset:768
    s_mov_b64 exec, 1
    ds_add_u32 v3, v166 offset:12
    s_mov_b64 exec, -1
    s_bitcmp1_b32 s70, 0
    s_cbranch_scc1 L_kv_v
    s_waitcnt vmcnt(12)
    ds_read_b64_tr_b16 v[80:81], v6 offset:0
    ds_read_b64_tr_b16 v[82:83], v6 offset:128
    ds_read_b128 v[112:115], v7 offset:0
    ds_read_b64_tr_b16 v[84:85], v6 offset:1024
    ds_read_b64_tr_b16 v[86:87], v6 offset:1152
    ds_read_b128 v[116:119], v7 offset:64
    ds_read_b64_tr_b16 v[88:89], v6 offset:2048
    ds_read_b64_tr_b16 v[90:91], v6 offset:2176
    ds_read_b128 v[120:123], v7 offset:128
    ds_read_b64_tr_b16 v[92:93], v6 offset:3072
    ds_read_b64_tr_b16 v[94:95], v6 offset:3200
    ds_read_b128 v[124:127], v7 offset:192
    s_waitcnt vmcnt(8)
    ds_read_b64_tr_b16 v[96:97], v6 offset:4096
    ds_read_b64_tr_b16 v[98:99], v6 offset:4224
    ds_read_b128 v[128:131], v7 offset:256
    ds_read_b64_tr_b16 v[100:101], v6 offset:5120
    ds_read_b64_tr_b16 v[102:103], v6 offset:5248
    ds_read_b128 v[132:135], v7 offset:320
    ds_read_b64_tr_b16 v[104:105], v6 offset:6144
    ds_read_b64_tr_b16 v[106:107], v6 offset:6272
    ds_read_b128 v[136:139], v7 offset:384
    ds_read_b64_tr_b16 v[108:109], v6 offset:7168
    ds_read_b64_tr_b16 v[110:111], v6 offset:7296
    ds_read_b128 v[140:143], v7 offset:448
    s_waitcnt lgkmcnt(12)
    v_mfma_f32_16x16x32_bf16 v[144:147], v[80:83], v[16:19], 0
    v_mfma_f32_16x16x32_bf16 v[148:151], v[112:115], v[16:19], 0
    v_mfma_f32_16x16x32_bf16 v[144:147], v[84:87], v[20:23], v[144:147]
    v_mfma_f32_16x16x32_bf16 v[148:151], v[116:119], v[20:23], v[148:151]
    v_mfma_f32_16x16x32_bf16 v[144:147], v[88:91], v[24:27], v[144:147]
    v_mfma_f32_16x16x32_bf16 v[148:151], v[120:123], v[24:27], v[148:151]
    v_mfma_f32_16x16x32_bf16 v[144:147], v[92:95], v[28:31], v[144:147]
    v_mfma_f32_16x16x32_bf16 v[148:151], v[124:127], v[28:31], v[148:151]
    s_waitcnt vmcnt(4)
    ds_read_b64_tr_b16 v[80:81], v6 offset:8192
    ds_read_b64_tr_b16 v[82:83], v6 offset:8320
    ds_read_b128 v[112:115], v7 offset:512
    ds_read_b64_tr_b16 v[84:85], v6 offset:9216
    ds_read_b64_tr_b16 v[86:87], v6 offset:9344
    ds_read_b128 v[116:119], v7 offset:576
    ds_read_b64_tr_b16 v[88:89], v6 offset:10240
    ds_read_b64_tr_b16 v[90:91], v6 offset:10368
    ds_read_b128 v[120:123], v7 offset:640
    ds_read_b64_tr_b16 v[92:93], v6 offset:11264
    ds_read_b64_tr_b16 v[94:95], v6 offset:11392
    ds_read_b128 v[124:127], v7 offset:704
    s_waitcnt lgkmcnt(12)
    v_mfma_f32_16x16x32_bf16 v[144:147], v[96:99], v[32:35], v[144:147]
    v_mfma_f32_16x16x32_bf16 v[148:151], v[128:131], v[32:35], v[148:151]
    v_mfma_f32_16x16x32_bf16 v[144:147], v[100:103], v[36:39], v[144:147]
    v_mfma_f32_16x16x32_bf16 v[148:151], v[132:135], v[36:39], v[148:151]
    v_mfma_f32_16x16x32_bf16 v[144:147], v[104:107], v[40:43], v[144:147]
    v_mfma_f32_16x16x32_bf16 v[148:151], v[136:139], v[40:43], v[148:151]
    v_mfma_f32_16x16x32_bf16 v[144:147], v[108:111], v[44:47], v[144:147]
    v_mfma_f32_16x16x32_bf16 v[148:151], v[140:143], v[44:47], v[148:151]
    s_waitcnt vmcnt(0)
    ds_read_b64_tr_b16 v[96:97], v6 offset:12288
    ds_read_b64_tr_b16 v[98:99], v6 offset:12416
    ds_read_b128 v[128:131], v7 offset:768
    ds_read_b64_tr_b16 v[100:101], v6 offset:13312
    ds_read_b64_tr_b16 v[102:103], v6 offset:13440
    ds_read_b128 v[132:135], v7 offset:832
    ds_read_b64_tr_b16 v[104:105], v6 offset:14336
    ds_read_b64_tr_b16 v[106:107], v6 offset:14464
    ds_read_b128 v[136:139], v7 offset:896
    ds_read_b64_tr_b16 v[108:109], v6 offset:15360
    ds_read_b64_tr_b16 v[110:111], v6 offset:15488
    ds_read_b128 v[140:143], v7 offset:960
    s_waitcnt lgkmcnt(12)
    v_mfma_f32_16x16x32_bf16 v[144:147], v[80:83], v[48:51], v[144:147]
    v_mfma_f32_16x16x32_bf16 v[148:151], v[112:115], v[48:51], v[148:151]
    v_mfma_f32_16x16x32_bf16 v[144:147], v[84:87], v[52:55], v[144:147]
    v_mfma_f32_16x16x32_bf16 v[148:151], v[116:119], v[52:55], v[148:151]
    v_mfma_f32_16x16x32_bf16 v[144:147], v[88:91], v[56:59], v[144:147]
    v_mfma_f32_16x16x32_bf16 v[148:151], v[120:123], v[56:59], v[148:151]
    v_mfma_f32_16x16x32_bf16 v[144:147], v[92:95], v[60:63], v[144:147]
    v_mfma_f32_16x16x32_bf16 v[148:151], v[124:127], v[60:63], v[148:151]
    s_waitcnt lgkmcnt(9)
    v_mfma_f32_16x16x32_bf16 v[144:147], v[96:99], v[64:67], v[144:147]
    v_mfma_f32_16x16x32_bf16 v[148:151], v[128:131], v[64:67], v[148:151]
    s_waitcnt lgkmcnt(6)
    v_mfma_f32_16x16x32_bf16 v[144:147], v[100:103], v[68:71], v[144:147]
    v_mfma_f32_16x16x32_bf16 v[148:151], v[132:135], v[68:71], v[148:151]
    s_waitcnt lgkmcnt(3)
    v_mfma_f32_16x16x32_bf16 v[144:147], v[104:107], v[72:75], v[144:147]
    v_mfma_f32_16x16x32_bf16 v[148:151], v[136:139], v[72:75], v[148:151]
    s_waitcnt lgkmcnt(0)
    v_mfma_f32_16x16x32_bf16 v[144:147], v[108:111], v[76:79], v[144:147]
    v_mfma_f32_16x16x32_bf16 v[148:151], v[140:143], v[76:79], v[148:151]
    v_lshlrev_b32 v6, 9, v9
    v_lshl_add_u32 v6, v8, 3, v6
    v_lshl_add_u32 v6, v4, 4, v6
    v_lshlrev_b32 v7, 2, v1
    s_nop 2
    v_cvt_pk_bf16_f32 v144, v144, v145
    v_cvt_pk_bf16_f32 v145, v146, v147
    buffer_store_dwordx2 v[144:145], v6, s[48:51], s76 offen
    buffer_store_dwordx2 v[144:145], v6, s[48:51], s75 offen sc1
    v_cvt_pk_bf16_f32 v148, v148, v148
    v_lshlrev_b32 v148, 16, v148
    v_mul_f32 v148, 0xbfb8aa3b, v148
    v_exp_f32 v148, v148
    s_nop 0
    v_add_f32 v148, 1.0, v148
    v_rcp_f32 v148, v148
    s_nop 0
    v_cvt_pk_bf16_f32 v148, v148, v148
    v_lshlrev_b32 v148, 16, v148
    s_mov_b64 exec, 1
    s_waitcnt vmcnt(1)
    buffer_store_dword v12, v11, s[48:51], s77 offen
    s_mov_b64 exec, 0xffff
    buffer_store_dword v148, v7, s[48:51], s74 offen sc1
    s_mov_b64 exec, -1
    s_branch L_kv_d
L_kv_v:
    s_waitcnt vmcnt(12)
    ds_read_b64_tr_b16 v[80:81], v6 offset:0
    ds_read_b64_tr_b16 v[82:83], v6 offset:128
    ds_read_b64_tr_b16 v[84:85], v6 offset:1024
    ds_read_b64_tr_b16 v[86:87], v6 offset:1152
    ds_read_b64_tr_b16 v[88:89], v6 offset:2048
    ds_read_b64_tr_b16 v[90:91], v6 offset:2176
    ds_read_b64_tr_b16 v[92:93], v6 offset:3072
    ds_read_b64_tr_b16 v[94:95], v6 offset:3200
    s_waitcnt vmcnt(8)
    ds_read_b64_tr_b16 v[96:97], v6 offset:4096
    ds_read_b64_tr_b16 v[98:99], v6 offset:4224
    ds_read_b64_tr_b16 v[100:101], v6 offset:5120
    ds_read_b64_tr_b16 v[102:103], v6 offset:5248
    ds_read_b64_tr_b16 v[104:105], v6 offset:6144
    ds_read_b64_tr_b16 v[106:107], v6 offset:6272
    ds_read_b64_tr_b16 v[108:109], v6 offset:7168
    ds_read_b64_tr_b16 v[110:111], v6 offset:7296
    s_waitcnt lgkmcnt(8)
    v_mfma_f32_16x16x32_bf16 v[144:147], v[16:19], v[80:83], 0
    v_mfma_f32_16x16x32_bf16 v[144:147], v[20:23], v[84:87], v[144:147]
    v_mfma_f32_16x16x32_bf16 v[144:147], v[24:27], v[88:91], v[144:147]
    v_mfma_f32_16x16x32_bf16 v[144:147], v[28:31], v[92:95], v[144:147]
    s_waitcnt vmcnt(4)
    ds_read_b64_tr_b16 v[80:81], v6 offset:8192
    ds_read_b64_tr_b16 v[82:83], v6 offset:8320
    ds_read_b64_tr_b16 v[84:85], v6 offset:9216
    ds_read_b64_tr_b16 v[86:87], v6 offset:9344
    ds_read_b64_tr_b16 v[88:89], v6 offset:10240
    ds_read_b64_tr_b16 v[90:91], v6 offset:10368
    ds_read_b64_tr_b16 v[92:93], v6 offset:11264
    ds_read_b64_tr_b16 v[94:95], v6 offset:11392
    s_waitcnt lgkmcnt(8)
    v_mfma_f32_16x16x32_bf16 v[144:147], v[32:35], v[96:99], v[144:147]
    v_mfma_f32_16x16x32_bf16 v[144:147], v[36:39], v[100:103], v[144:147]
    v_mfma_f32_16x16x32_bf16 v[144:147], v[40:43], v[104:107], v[144:147]
    v_mfma_f32_16x16x32_bf16 v[144:147], v[44:47], v[108:111], v[144:147]
    s_waitcnt vmcnt(0)
    ds_read_b64_tr_b16 v[96:97], v6 offset:12288
    ds_read_b64_tr_b16 v[98:99], v6 offset:12416
    ds_read_b64_tr_b16 v[100:101], v6 offset:13312
    ds_read_b64_tr_b16 v[102:103], v6 offset:13440
    ds_read_b64_tr_b16 v[104:105], v6 offset:14336
    ds_read_b64_tr_b16 v[106:107], v6 offset:14464
    ds_read_b64_tr_b16 v[108:109], v6 offset:15360
    ds_read_b64_tr_b16 v[110:111], v6 offset:15488
    s_waitcnt lgkmcnt(8)
    v_mfma_f32_16x16x32_bf16 v[144:147], v[48:51], v[80:83], v[144:147]
    v_mfma_f32_16x16x32_bf16 v[144:147], v[52:55], v[84:87], v[144:147]
    v_mfma_f32_16x16x32_bf16 v[144:147], v[56:59], v[88:91], v[144:147]
    v_mfma_f32_16x16x32_bf16 v[144:147], v[60:63], v[92:95], v[144:147]
    s_waitcnt lgkmcnt(6)
    v_mfma_f32_16x16x32_bf16 v[144:147], v[64:67], v[96:99], v[144:147]
    s_waitcnt lgkmcnt(4)
    v_mfma_f32_16x16x32_bf16 v[144:147], v[68:71], v[100:103], v[144:147]
    s_waitcnt lgkmcnt(2)
    v_mfma_f32_16x16x32_bf16 v[144:147], v[72:75], v[104:107], v[144:147]
    s_waitcnt lgkmcnt(0)
    v_mfma_f32_16x16x32_bf16 v[144:147], v[76:79], v[108:111], v[144:147]
    v_lshlrev_b32 v6, 9, v8
    v_lshl_add_u32 v6, v9, 3, v6
    v_lshl_add_u32 v6, v4, 4, v6
    s_nop 4
    v_cvt_pk_bf16_f32 v144, v144, v145
    v_cvt_pk_bf16_f32 v145, v146, v147
    buffer_store_dwordx2 v[144:145], v6, s[48:51], s76 offen
    buffer_store_dwordx2 v[144:145], v6, s[48:51], s75 offen sc1
    s_mov_b64 exec, 1
    s_waitcnt vmcnt(1)
    buffer_store_dword v12, v11, s[48:51], s77 offen
    s_mov_b64 exec, -1
L_kv_d:
    s_mov_b64 exec, 1
    ds_add_u32 v3, v166 offset:128
    s_mov_b64 exec, -1
    s_mov_b64 exec, 1
    s_waitcnt vmcnt(0)
    buffer_store_dword v12, v11, s[48:51], 0 offen sc1
    s_mov_b64 exec, -1
    s_mov_b32 s100, 2
    s_branch L_h023
L_h1:
    s_lshl_b32 s74, s69, 16
    s_lshr_b32 s75, s70, 1
    s_xor_b32 s75, s75, 1
    s_lshl_b32 s75, s75, 14
    s_add_u32 s74, s74, s75
    s_and_b32 s75, s75, 0x4000
    s_add_u32 s75, s75, 16384
    s_mov_b32 s81, 0
L_xph:
    s_mov_b32 m0, s75
    v_xor_b32 v6, 0, v2
    buffer_load_dwordx4 v6, s[36:39], s74 offen lds
    s_add_u32 s75, s75, 1024
    s_add_u32 s74, s74, 1024
    s_mov_b32 m0, s75
    v_xor_b32 v6, 16, v2
    buffer_load_dwordx4 v6, s[36:39], s74 offen lds
    s_add_u32 s75, s75, 1024
    s_add_u32 s74, s74, 1024
    s_mov_b32 m0, s75
    v_xor_b32 v6, 32, v2
    buffer_load_dwordx4 v6, s[36:39], s74 offen lds
    s_add_u32 s75, s75, 1024
    s_add_u32 s74, s74, 1024
    s_mov_b32 m0, s75
    v_xor_b32 v6, 48, v2
    buffer_load_dwordx4 v6, s[36:39], s74 offen lds
    s_add_u32 s75, s75, 1024
    s_add_u32 s74, s74, 1024
    s_mov_b32 m0, s75
    v_xor_b32 v6, 64, v2
    buffer_load_dwordx4 v6, s[36:39], s74 offen lds
    s_add_u32 s75, s75, 1024
    s_add_u32 s74, s74, 1024
    s_mov_b32 m0, s75
    v_xor_b32 v6, 80, v2
    buffer_load_dwordx4 v6, s[36:39], s74 offen lds
    s_add_u32 s75, s75, 1024
    s_add_u32 s74, s74, 1024
    s_mov_b32 m0, s75
    v_xor_b32 v6, 96, v2
    buffer_load_dwordx4 v6, s[36:39], s74 offen lds
    s_add_u32 s75, s75, 1024
    s_add_u32 s74, s74, 1024
    s_mov_b32 m0, s75
    v_xor_b32 v6, 112, v2
    buffer_load_dwordx4 v6, s[36:39], s74 offen lds
    s_add_u32 s75, s75, 1024
    s_add_u32 s74, s74, 1024
    s_mov_b32 m0, s75
    v_xor_b32 v6, 128, v2
    buffer_load_dwordx4 v6, s[36:39], s74 offen lds
    s_add_u32 s75, s75, 1024
    s_add_u32 s74, s74, 1024
    s_mov_b32 m0, s75
    v_xor_b32 v6, 144, v2
    buffer_load_dwordx4 v6, s[36:39], s74 offen lds
    s_add_u32 s75, s75, 1024
    s_add_u32 s74, s74, 1024
    s_mov_b32 m0, s75
    v_xor_b32 v6, 160, v2
    buffer_load_dwordx4 v6, s[36:39], s74 offen lds
    s_add_u32 s75, s75, 1024
    s_add_u32 s74, s74, 1024
    s_mov_b32 m0, s75
    v_xor_b32 v6, 176, v2
    buffer_load_dwordx4 v6, s[36:39], s74 offen lds
    s_add_u32 s75, s75, 1024
    s_add_u32 s74, s74, 1024
    s_mov_b32 m0, s75
    v_xor_b32 v6, 192, v2
    buffer_load_dwordx4 v6, s[36:39], s74 offen lds
    s_add_u32 s75, s75, 1024
    s_add_u32 s74, s74, 1024
    s_mov_b32 m0, s75
    v_xor_b32 v6, 208, v2
    buffer_load_dwordx4 v6, s[36:39], s74 offen lds
    s_add_u32 s75, s75, 1024
    s_add_u32 s74, s74, 1024
    s_mov_b32 m0, s75
    v_xor_b32 v6, 224, v2
    buffer_load_dwordx4 v6, s[36:39], s74 offen lds
    s_add_u32 s75, s75, 1024
    s_add_u32 s74, s74, 1024
    s_mov_b32 m0, s75
    v_xor_b32 v6, 240, v2
    buffer_load_dwordx4 v6, s[36:39], s74 offen lds
    s_add_u32 s75, s75, 1024
    s_add_u32 s74, s74, 1024
    s_mov_b64 exec, 1
    ds_add_u32 v3, v166 offset:0
    s_mov_b64 exec, -1
    v_bfe_u32 v6, v1, 2, 2
    v_lshl_add_u32 v7, v5, 3, v6
    v_and_b32 v8, 15, v7
    s_lshl_b32 s89, s70, 3
    v_bfe_u32 v9, v1, 1, 1
    v_or_b32 v9, s89, v9
    v_xor_b32 v9, v9, v8
    v_lshlrev_b32 v9, 4, v9
    v_lshl_add_u32 v9, v7, 10, v9
    v_and_b32 v6, 1, v1
    v_lshl_add_u32 v9, v6, 3, v9
    s_waitcnt vmcnt(0) lgkmcnt(0)
    s_mov_b64 exec, 1
    ds_add_u32 v3, v166 offset:4
    s_mov_b64 exec, -1
L_wt1:
    ds_read_b32 v165, v3 offset:12
    s_waitcnt lgkmcnt(0)
    v_readfirstlane_b32 s93, v165
    s_nop 0
    s_cmp_ge_u32 s93, 1
    s_cbranch_scc1 L_wd1
    s_sleep 1
    s_sub_u32 s83, s83, 1
    s_cbranch_scc0 L_wt1
    s_mov_b32 s83, 0
L_wd1:
    v_xor_b32 v6, 0, v9
    v_xor_b32 v7, 64, v9
    ds_read_b64_tr_b16 v[28:29], v6 offset:16384
    ds_read_b64_tr_b16 v[30:31], v7 offset:20480
    v_xor_b32 v6, 32, v9
    v_xor_b32 v7, 96, v9
    ds_read_b64_tr_b16 v[36:37], v6 offset:16384
    ds_read_b64_tr_b16 v[38:39], v7 offset:20480
    v_xor_b32 v6, 64, v9
    v_xor_b32 v7, 0, v9
    ds_read_b64_tr_b16 v[44:45], v6 offset:16384
    ds_read_b64_tr_b16 v[46:47], v7 offset:20480
    v_xor_b32 v6, 96, v9
    v_xor_b32 v7, 32, v9
    ds_read_b64_tr_b16 v[52:53], v6 offset:16384
    ds_read_b64_tr_b16 v[54:55], v7 offset:20480
    s_mov_b64 exec, 1
    ds_add_u32 v3, v166 offset:12
    s_mov_b64 exec, -1
L_wt2:
    ds_read_b32 v165, v3 offset:0
    s_waitcnt lgkmcnt(0)
    v_readfirstlane_b32 s93, v165
    s_nop 0
    s_cmp_ge_u32 s93, 3
    s_cbranch_scc1 L_wd2
    s_sleep 1
    s_sub_u32 s83, s83, 1
    s_cbranch_scc0 L_wt2
    s_mov_b32 s83, 0
L_wd2:
L_wt3:
    ds_read_b32 v165, v3 offset:20
    s_waitcnt lgkmcnt(0)
    v_readfirstlane_b32 s93, v165
    s_nop 0
    s_cmp_ge_u32 s93, 8
    s_cbranch_scc1 L_wd3
    s_sleep 1
    s_sub_u32 s83, s83, 1
    s_cbranch_scc0 L_wt3
    s_mov_b32 s83, 0
L_wd3:
    s_lshl_b32 s74, s69, 16
    s_xor_b32 s75, s98, 1
    s_lshl_b32 s75, s75, 15
    s_add_u32 s74, s74, s75
    s_mov_b32 s75, 49152
    s_mov_b32 s81, 0
L_xpf:
    s_mov_b32 m0, s75
    v_xor_b32 v6, 0, v2
    buffer_load_dwordx4 v6, s[36:39], s74 offen lds
    s_add_u32 s75, s75, 1024
    s_add_u32 s74, s74, 1024
    s_mov_b32 m0, s75
    v_xor_b32 v6, 16, v2
    buffer_load_dwordx4 v6, s[36:39], s74 offen lds
    s_add_u32 s75, s75, 1024
    s_add_u32 s74, s74, 1024
    s_mov_b32 m0, s75
    v_xor_b32 v6, 32, v2
    buffer_load_dwordx4 v6, s[36:39], s74 offen lds
    s_add_u32 s75, s75, 1024
    s_add_u32 s74, s74, 1024
    s_mov_b32 m0, s75
    v_xor_b32 v6, 48, v2
    buffer_load_dwordx4 v6, s[36:39], s74 offen lds
    s_add_u32 s75, s75, 1024
    s_add_u32 s74, s74, 1024
    s_mov_b32 m0, s75
    v_xor_b32 v6, 64, v2
    buffer_load_dwordx4 v6, s[36:39], s74 offen lds
    s_add_u32 s75, s75, 1024
    s_add_u32 s74, s74, 1024
    s_mov_b32 m0, s75
    v_xor_b32 v6, 80, v2
    buffer_load_dwordx4 v6, s[36:39], s74 offen lds
    s_add_u32 s75, s75, 1024
    s_add_u32 s74, s74, 1024
    s_mov_b32 m0, s75
    v_xor_b32 v6, 96, v2
    buffer_load_dwordx4 v6, s[36:39], s74 offen lds
    s_add_u32 s75, s75, 1024
    s_add_u32 s74, s74, 1024
    s_mov_b32 m0, s75
    v_xor_b32 v6, 112, v2
    buffer_load_dwordx4 v6, s[36:39], s74 offen lds
    s_add_u32 s75, s75, 1024
    s_add_u32 s74, s74, 1024
    s_mov_b32 m0, s75
    v_xor_b32 v6, 128, v2
    buffer_load_dwordx4 v6, s[36:39], s74 offen lds
    s_add_u32 s75, s75, 1024
    s_add_u32 s74, s74, 1024
    s_mov_b32 m0, s75
    v_xor_b32 v6, 144, v2
    buffer_load_dwordx4 v6, s[36:39], s74 offen lds
    s_add_u32 s75, s75, 1024
    s_add_u32 s74, s74, 1024
    s_mov_b32 m0, s75
    v_xor_b32 v6, 160, v2
    buffer_load_dwordx4 v6, s[36:39], s74 offen lds
    s_add_u32 s75, s75, 1024
    s_add_u32 s74, s74, 1024
    s_mov_b32 m0, s75
    v_xor_b32 v6, 176, v2
    buffer_load_dwordx4 v6, s[36:39], s74 offen lds
    s_add_u32 s75, s75, 1024
    s_add_u32 s74, s74, 1024
    s_mov_b32 m0, s75
    v_xor_b32 v6, 192, v2
    buffer_load_dwordx4 v6, s[36:39], s74 offen lds
    s_add_u32 s75, s75, 1024
    s_add_u32 s74, s74, 1024
    s_mov_b32 m0, s75
    v_xor_b32 v6, 208, v2
    buffer_load_dwordx4 v6, s[36:39], s74 offen lds
    s_add_u32 s75, s75, 1024
    s_add_u32 s74, s74, 1024
    s_mov_b32 m0, s75
    v_xor_b32 v6, 224, v2
    buffer_load_dwordx4 v6, s[36:39], s74 offen lds
    s_add_u32 s75, s75, 1024
    s_add_u32 s74, s74, 1024
    s_mov_b32 m0, s75
    v_xor_b32 v6, 240, v2
    buffer_load_dwordx4 v6, s[36:39], s74 offen lds
    s_add_u32 s75, s75, 1024
    s_add_u32 s74, s74, 1024
    s_add_u32 s81, s81, 1
    s_cmp_lt_u32 s81, 2
    s_cbranch_scc1 L_xpf
    v_readfirstlane_b32 s99, v164
    s_nop 0
    s_mul_i32 s99, s99, 0x9e3779b1
    s_add_u32 s99, s99, 0x7f4a7c15
    v_mov_b32 v16, -1
    v_mov_b32 v17, -1
    v_mov_b32 v18, -1
    v_mov_b32 v19, -1
    s_lshl_b32 s74, s69, 16
    s_lshl_b32 s75, s70, 12
    s_add_u32 s74, s74, s75
    s_add_u32 s74, s74, 1048576
    s_add_u32 s75, s74, 32768
    s_lshl_b32 s76, s71, 12
    s_add_u32 s76, s76, 4194304
    s_add_u32 s77, s76, 4096
    v_lshlrev_b32 v8, 12, v4
    v_lshl_add_u32 v8, v5, 4, v8
    s_lshl_b32 s89, s98, 6
    v_add_u32 v13, s89, v8
    v_xor_b32 v8, 64, v13
    s_lshl_b32 s89, s70, 18
    s_lshl_b32 s90, s69, 7
    s_add_u32 s89, s89, s90
    s_add_u32 s89, s89, 6291456
    s_waitcnt vmcnt(0)
    s_mov_b64 exec, 1
    ds_add_u32 v3, v166 offset:24
    s_mov_b64 exec, -1
    v_xor_b32 v6, 0, v9
    v_xor_b32 v7, 64, v9
    ds_read_b64_tr_b16 v[24:25], v6 offset:49152
    ds_read_b64_tr_b16 v[26:27], v7 offset:53248
    v_xor_b32 v6, 32, v9
    v_xor_b32 v7, 96, v9
    ds_read_b64_tr_b16 v[32:33], v6 offset:49152
    ds_read_b64_tr_b16 v[34:35], v7 offset:53248
    v_xor_b32 v6, 64, v9
    v_xor_b32 v7, 0, v9
    ds_read_b64_tr_b16 v[40:41], v6 offset:49152
    ds_read_b64_tr_b16 v[42:43], v7 offset:53248
    v_xor_b32 v6, 96, v9
    v_xor_b32 v7, 32, v9
    ds_read_b64_tr_b16 v[48:49], v6 offset:49152
    ds_read_b64_tr_b16 v[50:51], v7 offset:53248
    s_mov_b64 exec, 1
    ds_add_u32 v3, v166 offset:16
    s_mov_b64 exec, -1
L_wt4:
    ds_read_b32 v165, v3 offset:40
    s_waitcnt lgkmcnt(0)
    v_readfirstlane_b32 s93, v165
    s_nop 0
    s_cmp_ge_u32 s93, 3
    s_cbranch_scc1 L_wd4
    s_sleep 3
    s_sub_u32 s83, s83, 1
    s_cbranch_scc0 L_wt4
    s_mov_b32 s83, 0
L_wd4:
    buffer_store_dwordx4 v[24:27], v8, s[48:51], s89 offen sc1
    buffer_store_dwordx4 v[28:31], v13, s[48:51], s89 offen sc1
    s_add_u32 s89, s89, 65536
    buffer_store_dwordx4 v[32:35], v8, s[48:51], s89 offen sc1
    buffer_store_dwordx4 v[36:39], v13, s[48:51], s89 offen sc1
    s_add_u32 s89, s89, 65536
    buffer_store_dwordx4 v[40:43], v8, s[48:51], s89 offen sc1
    buffer_store_dwordx4 v[44:47], v13, s[48:51], s89 offen sc1
    s_add_u32 s89, s89, 65536
    buffer_store_dwordx4 v[48:51], v8, s[48:51], s89 offen sc1
    buffer_store_dwordx4 v[52:55], v13, s[48:51], s89 offen sc1
    s_add_u32 s89, s89, 65536
    buffer_store_dwordx4 v[16:19], v2, s[48:51], s74 offen offset:0 sc1
    buffer_store_dwordx4 v[16:19], v2, s[48:51], s74 offen offset:1024 sc1
    buffer_store_dwordx4 v[16:19], v2, s[48:51], s74 offen offset:2048 sc1
    buffer_store_dwordx4 v[16:19], v2, s[48:51], s74 offen offset:3072 sc1
    buffer_store_dwordx4 v[16:19], v2, s[48:51], s75 offen offset:0 sc1
    buffer_store_dwordx4 v[16:19], v2, s[48:51], s75 offen offset:1024 sc1
    buffer_store_dwordx4 v[16:19], v2, s[48:51], s75 offen offset:2048 sc1
    buffer_store_dwordx4 v[16:19], v2, s[48:51], s75 offen offset:3072 sc1
    buffer_store_dwordx4 v[16:19], v2, s[48:51], s76 offen offset:0 sc1
    buffer_store_dwordx4 v[16:19], v2, s[48:51], s76 offen offset:1024 sc1
    buffer_store_dwordx4 v[16:19], v2, s[48:51], s76 offen offset:2048 sc1
    buffer_store_dwordx4 v[16:19], v2, s[48:51], s76 offen offset:3072 sc1
    buffer_store_dwordx4 v[16:19], v2, s[48:51], s77 offen offset:0 sc1
    buffer_store_dwordx4 v[16:19], v2, s[48:51], s77 offen offset:1024 sc1
    buffer_store_dwordx4 v[16:19], v2, s[48:51], s77 offen offset:2048 sc1
    buffer_store_dwordx4 v[16:19], v2, s[48:51], s77 offen offset:3072 sc1
    s_mul_i32 s74, s70, 4352
    s_lshl_b32 s75, s69, 2
    s_add_u32 s74, s74, s75
    s_add_u32 s74, s74, 262144
    v_mov_b32 v11, s74
    v_mov_b32 v6, s99
    s_mov_b64 exec, 1
    s_waitcnt vmcnt(0)
    buffer_store_dword v6, v11, s[48:51], 0 offen sc1
    s_mov_b64 exec, -1
    s_mov_b64 exec, 1
    ds_add_u32 v3, v166 offset:32
    s_mov_b64 exec, -1
    s_branch L_hkvd
L_h23:
    v_lshrrev_b32 v6, 3, v1
    v_lshlrev_b32 v6, 10, v6
    v_and_b32 v7, 7, v1
    v_bfe_u32 v8, v1, 4, 1
    v_lshlrev_b32 v8, 1, v8
    v_xor_b32 v7, v7, v8
    v_lshl_add_u32 v8, v7, 4, v6
    v_xor_b32 v9, 64, v8
    s_sub_u32 s100, s68, 1
    s_lshl_b32 s74, s100, 2
    v_add_u32 v10, s74, v3
L_wt5:
    ds_read_b32 v165, v3 offset:0
    s_waitcnt lgkmcnt(0)
    v_readfirstlane_b32 s93, v165
    s_nop 0
    s_cmp_ge_u32 s93, s100
    s_cbranch_scc1 L_wd5
    s_sleep 1
    s_sub_u32 s83, s83, 1
    s_cbranch_scc0 L_wt5
    s_mov_b32 s83, 0
L_wd5:
    s_and_b32 s76, s68, 1
    s_lshl_b32 s74, s76, 18
    s_lshl_b32 s75, s70, 7
    s_add_u32 s74, s74, s75
    s_lshl_b32 s75, s76, 15
    s_add_u32 s75, s75, 81920
    s_mov_b32 s81, 0
L_wp:
    s_mov_b32 m0, s75
    s_add_u32 s75, s75, 1024
    buffer_load_dwordx4 v8, s[40:43], s74 offen lds
    s_add_u32 s74, s74, 8192
    s_mov_b32 m0, s75
    s_add_u32 s75, s75, 1024
    buffer_load_dwordx4 v9, s[40:43], s74 offen lds
    s_add_u32 s74, s74, 8192
    s_mov_b32 m0, s75
    s_add_u32 s75, s75, 1024
    buffer_load_dwordx4 v8, s[40:43], s74 offen lds
    s_add_u32 s74, s74, 8192
    s_mov_b32 m0, s75
    s_add_u32 s75, s75, 1024
    buffer_load_dwordx4 v9, s[40:43], s74 offen lds
    s_add_u32 s74, s74, 8192
    s_add_u32 s81, s81, 1
    s_cmp_lt_u32 s81, 8
    s_cbranch_scc1 L_wp
    s_mov_b64 exec, 1
    ds_add_u32 v3, v166 offset:0
    s_mov_b64 exec, -1
    s_waitcnt vmcnt(0)
    s_mov_b64 exec, 1
    ds_add_u32 v10, v166 offset:0
    s_mov_b64 exec, -1
    v_readfirstlane_b32 s99, v164
    s_nop 0
    s_mul_i32 s99, s99, 0x9e3779b1
    s_add_u32 s99, s99, 0x7f4a7c15
    s_sub_u32 s100, s100, 1
L_h023:
L_kvl:
    s_add_u32 s75, s101, s100
    s_and_b32 s75, s75, 7
    s_mul_i32 s76, s75, 4352
    s_add_u32 s76, s76, 196608
    s_lshl_b32 s75, s75, 14
    s_cmp_ge_u32 s100, 3
    s_cbranch_scc1 L_kvp
    s_cmp_eq_u32 s100, 0
    s_cbranch_scc0 L_kvw1
L_wt6:
    ds_read_b32 v165, v3 offset:128
    s_waitcnt lgkmcnt(0)
    v_readfirstlane_b32 s93, v165
    s_nop 0
    s_cmp_ge_u32 s93, 1
    s_cbranch_scc1 L_wd6
    s_sleep 1
    s_sub_u32 s83, s83, 1
    s_cbranch_scc0 L_wt6
    s_mov_b32 s83, 0
L_wd6:
    s_getreg_b32 s77, hwreg(HW_REG_XCC_ID, 0, 4)
    s_xor_b32 s77, s77, s99
    s_add_u32 s89, s76, 524288
    s_mov_b32 s81, 0
    v_and_b32 v6, 31, v1
    v_lshlrev_b32 v6, 2, v6
L_lpoll:
    buffer_load_dword v7, v6, s[48:51], s89 offen sc1
    s_waitcnt vmcnt(0)
    v_cmp_ne_u32 vcc, s77, v7
    v_xor_b32 v7, s99, v7
    s_cbranch_vccz L_lok
    s_sleep 2
    s_add_u32 s81, s81, 1
    s_cmp_lt_u32 s81, 12
    s_cbranch_scc1 L_lpoll
    s_branch L_kvp
L_lok:
    s_add_u32 s75, s75, 524288
    s_branch L_kvgo
L_kvw1:
L_wt7:
    ds_read_b32 v165, v3 offset:40
    s_waitcnt lgkmcnt(0)
    v_readfirstlane_b32 s93, v165
    s_nop 0
    s_cmp_ge_u32 s93, 1
    s_cbranch_scc1 L_wd7
    s_sleep 1
    s_sub_u32 s83, s83, 1
    s_cbranch_scc0 L_wt7
    s_mov_b32 s83, 0
L_wd7:
L_kvp:
    v_and_b32 v6, 31, v1
    v_lshlrev_b32 v6, 2, v6
L_poll1:
    buffer_load_dword v7, v6, s[48:51], s76 offen sc1
    s_waitcnt vmcnt(0)
    v_xor_b32 v7, s99, v7
    v_cmp_lt_u32 vcc, 15, v7
    s_nop 0
    s_cbranch_vccz L_polled1
    s_sleep 6
    s_sub_u32 s83, s83, 16
    s_cbranch_scc0 L_poll1
    s_mov_b32 s83, 0
L_polled1:
    s_cmp_eq_u32 s100, 0
    s_cbranch_scc1 L_kvgo
    s_cmp_ge_u32 s100, 3
    s_cbranch_scc1 L_kvw2
L_wt8:
    ds_read_b32 v165, v3 offset:12
    s_waitcnt lgkmcnt(0)
    v_readfirstlane_b32 s93, v165
    s_nop 0
    s_cmp_ge_u32 s93, 6
    s_cbranch_scc1 L_wd8
    s_sleep 1
    s_sub_u32 s83, s83, 1
    s_cbranch_scc0 L_wt8
    s_mov_b32 s83, 0
L_wd8:
    s_branch L_kvgo
L_kvw2:
L_wt9:
    ds_read_b32 v165, v3 offset:16
    s_waitcnt lgkmcnt(0)
    v_readfirstlane_b32 s93, v165
    s_nop 0
    s_cmp_ge_u32 s93, 9
    s_cbranch_scc1 L_wd9
    s_sleep 2
    s_sub_u32 s83, s83, 1
    s_cbranch_scc0 L_wt9
    s_mov_b32 s83, 0
L_wd9:
L_kvgo:
L_wt10:
    ds_read_b32 v165, v3 offset:40
    s_waitcnt lgkmcnt(0)
    v_readfirstlane_b32 s93, v165
    s_nop 0
    s_cmp_ge_u32 s93, s100
    s_cbranch_scc1 L_wd10
    s_sleep 1
    s_sub_u32 s83, s83, 1
    s_cbranch_scc0 L_wt10
    s_mov_b32 s83, 0
L_wd10:
    s_lshl_b32 s74, s100, 14
    s_mov_b32 m0, s74
    s_nop 0
    buffer_load_dwordx4 v2, s[48:51], s75 offen offset:0 sc1 lds
    buffer_load_dwordx4 v2, s[48:51], s75 offen offset:1024 sc1 lds
    buffer_load_dwordx4 v2, s[48:51], s75 offen offset:2048 sc1 lds
    buffer_load_dwordx4 v2, s[48:51], s75 offen offset:3072 sc1 lds
    s_add_u32 s74, s74, 4096
    s_add_u32 s75, s75, 4096
    s_mov_b32 m0, s74
    s_nop 0
    buffer_load_dwordx4 v2, s[48:51], s75 offen offset:0 sc1 lds
    buffer_load_dwordx4 v2, s[48:51], s75 offen offset:1024 sc1 lds
    buffer_load_dwordx4 v2, s[48:51], s75 offen offset:2048 sc1 lds
    buffer_load_dwordx4 v2, s[48:51], s75 offen offset:3072 sc1 lds
    s_add_u32 s74, s74, 4096
    s_add_u32 s75, s75, 4096
    s_mov_b32 m0, s74
    s_nop 0
    buffer_load_dwordx4 v2, s[48:51], s75 offen offset:0 sc1 lds
    buffer_load_dwordx4 v2, s[48:51], s75 offen offset:1024 sc1 lds
    buffer_load_dwordx4 v2, s[48:51], s75 offen offset:2048 sc1 lds
    buffer_load_dwordx4 v2, s[48:51], s75 offen offset:3072 sc1 lds
    s_add_u32 s74, s74, 4096
    s_add_u32 s75, s75, 4096
    s_mov_b32 m0, s74
    s_nop 0
    buffer_load_dwordx4 v2, s[48:51], s75 offen offset:0 sc1 lds
    buffer_load_dwordx4 v2, s[48:51], s75 offen offset:1024 sc1 lds
    buffer_load_dwordx4 v2, s[48:51], s75 offen offset:2048 sc1 lds
    buffer_load_dwordx4 v2, s[48:51], s75 offen offset:3072 sc1 lds
    s_add_u32 s74, s74, 4096
    s_add_u32 s75, s75, 4096
    s_mov_b64 exec, 1
    ds_add_u32 v3, v166 offset:40
    s_mov_b64 exec, -1
    s_lshl_b32 s74, s100, 2
    v_add_u32 v9, s74, v3
    s_cmp_lg_u32 s100, 0
    s_cbranch_scc1 L_noloc
    s_getreg_b32 s75, hwreg(HW_REG_XCC_ID, 0, 4)
    v_cmp_ne_u32 vcc, s75, v7
    s_and_b32 s74, s69, 3
    s_lshl_b32 s74, s74, 3
    s_lshr_b32 s74, vcc_lo, s74
    s_and_b32 s74, s74, 0xff
    s_cbranch_scc1 L_noloc
    s_mov_b64 exec, 1
    ds_add_u32 v3, v166 offset:36
    s_mov_b64 exec, -1
L_noloc:
    s_cmp_lg_u32 s100, 7
    s_cbranch_scc1 L_no7
    s_mul_i32 s76, s101, 4352
    s_add_u32 s76, s76, 196608
    v_and_b32 v6, 31, v1
    v_lshlrev_b32 v6, 2, v6
L_poll2:
    buffer_load_dword v7, v6, s[48:51], s76 offen sc1
    s_waitcnt vmcnt(0)
    v_xor_b32 v7, s99, v7
    v_cmp_lt_u32 vcc, 15, v7
    s_nop 0
    s_cbranch_vccz L_polled2
    s_sleep 6
    s_sub_u32 s83, s83, 16
    s_cbranch_scc0 L_poll2
    s_mov_b32 s83, 0
L_polled2:
L_no7:
    s_cmp_eq_u32 s100, 7
    s_cselect_b32 s74, 2, 1
    v_mov_b32 v6, s74
    s_mov_b64 exec, 1
    s_waitcnt vmcnt(0)
    ds_add_u32 v9, v6 offset:96
    s_mov_b64 exec, -1
    s_cmp_ge_u32 s100, 3
    s_cbranch_scc1 L_nostamp
L_nostamp:
    s_add_u32 s100, s100, 3
    s_cmp_lt_u32 s100, 8
    s_cbranch_scc1 L_kvl
L_hkvd:
    s_mov_b32 s64, s12
    s_and_b32 s65, s13, 0xffff
    s_mov_b32 s66, 524288
    s_mov_b32 s67, 0x00020000
    s_mov_b32 s52, s30
    s_and_b32 s53, s31, 0xffff
    s_mov_b32 s54, 2097152
    s_mov_b32 s55, 0x00020000
    s_lshr_b32 s96, s68, 1
    s_and_b32 s97, s68, 1
    s_lshl_b32 s74, s96, 2
    v_add_u32 v10, s74, v3
L_wt11:
    ds_read_b32 v165, v3 offset:16
    s_waitcnt lgkmcnt(0)
    v_readfirstlane_b32 s93, v165
    s_nop 0
    s_cmp_ge_u32 s93, 9
    s_cbranch_scc1 L_wd11
    s_sleep 4
    s_sub_u32 s83, s83, 1
    s_cbranch_scc0 L_wt11
    s_mov_b32 s83, 0
L_wd11:
    s_cmp_eq_u32 s68, 1
    s_cbranch_scc1 L_sg1
    s_cmp_eq_u32 s68, 2
    s_cbranch_scc1 L_sg2
    s_cmp_eq_u32 s68, 3
    s_cbranch_scc1 L_sg3
    v_mov_b32 v6, 0
    v_mov_b32 v7, 0
    v_lshlrev_b32 v11, 3, v1
    v_add_u32 v8, 135168, v11
    v_sub_u32 v11, 135160, v11
    v_add_u32 v9, 147724, v2
    s_mov_b64 exec, 0xff
    ds_write_b64 v8, v[6:7]
    ds_write_b64 v8, v[6:7] offset:4160
    ds_write_b64 v8, v[6:7] offset:8320
    ds_write_b64 v8, v[6:7] offset:12480
    s_mov_b64 exec, -1
    ds_read_b128 v[16:19], v9 offset:4
    ds_read_b32 v20, v9 offset:0
    ds_read_b128 v[22:25], v9 offset:2596
    ds_read_b32 v26, v9 offset:2592
    ds_read_b128 v[32:35], v9 offset:5188
    ds_read_b32 v36, v9 offset:5184
    ds_read_b128 v[38:41], v9 offset:7780
    ds_read_b32 v42, v9 offset:7776
    s_waitcnt lgkmcnt(4)
    v_add_f32 v16, v16, v22
    v_add_f32 v17, v17, v23
    v_add_f32 v18, v18, v24
    v_add_f32 v19, v19, v25
    v_add_f32 v20, v20, v26
    v_cvt_pk_bf16_f32 v28, v19, v18
    v_cvt_pk_bf16_f32 v29, v17, v16
    v_cvt_pk_bf16_f32 v30, v18, v17
    v_cvt_pk_bf16_f32 v31, v16, v20
    ds_write_b64 v11, v[28:29] offset:0
    ds_write_b64 v11, v[30:31] offset:4160
    s_waitcnt lgkmcnt(2)
    v_add_f32 v32, v32, v38
    v_add_f32 v33, v33, v39
    v_add_f32 v34, v34, v40
    v_add_f32 v35, v35, v41
    v_add_f32 v36, v36, v42
    v_cvt_pk_bf16_f32 v44, v35, v34
    v_cvt_pk_bf16_f32 v45, v33, v32
    v_cvt_pk_bf16_f32 v46, v34, v33
    v_cvt_pk_bf16_f32 v47, v32, v36
    ds_write_b64 v11, v[44:45] offset:8320
    ds_write_b64 v11, v[46:47] offset:12480
    s_branch L_sgd
L_sg1:
    v_lshlrev_b32 v9, 3, v1
    v_add_u32 v9, 148748, v9
    v_lshlrev_b32 v11, 3, v1
    v_sub_u32 v11, 134648, v11
    v_cmp_eq_u32 vcc, 0, v1
    ds_read_b64 v[16:17], v9 offset:4
    ds_read_b32 v18, v9 offset:12
    ds_read_b32 v19, v9 offset:0
    ds_read_b64 v[20:21], v9 offset:2596
    ds_read_b32 v22, v9 offset:2604
    ds_read_b32 v23, v9 offset:2592
    ds_read_b64 v[48:49], v9 offset:5188
    ds_read_b32 v50, v9 offset:5196
    ds_read_b32 v51, v9 offset:5184
    ds_read_b64 v[52:53], v9 offset:7780
    ds_read_b32 v54, v9 offset:7788
    ds_read_b32 v55, v9 offset:7776
    s_waitcnt lgkmcnt(0)
    v_add_f32 v16, v16, v20
    v_add_f32 v17, v17, v21
    v_add_f32 v18, v18, v22
    v_add_f32 v19, v19, v23
    v_cndmask_b32 v19, v16, v19, vcc
    v_cvt_pk_bf16_f32 v24, v18, v17
    v_cvt_pk_bf16_f32 v32, v17, v16
    v_cvt_pk_bf16_f32 v25, v16, v16
    v_cvt_pk_bf16_f32 v33, v16, v19
    ds_write_b64 v11, v[24:25] offset:0
    ds_write_b64 v11, v[32:33] offset:4160
    v_add_f32 v48, v48, v52
    v_add_f32 v49, v49, v53
    v_add_f32 v50, v50, v54
    v_add_f32 v51, v51, v55
    v_cndmask_b32 v51, v48, v51, vcc
    v_cvt_pk_bf16_f32 v56, v50, v49
    v_cvt_pk_bf16_f32 v64, v49, v48
    v_cvt_pk_bf16_f32 v57, v48, v48
    v_cvt_pk_bf16_f32 v65, v48, v51
    ds_write_b64 v11, v[56:57] offset:8320
    ds_write_b64 v11, v[64:65] offset:12480
    s_branch L_sgd
L_sg2:
    v_lshlrev_b32 v9, 3, v1
    v_add_u32 v9, 149260, v9
    v_lshlrev_b32 v11, 4, v1
    v_sub_u32 v11, 134128, v11
    ds_read_b64 v[16:17], v9 offset:4
    ds_read_b32 v18, v9 offset:12
    ds_read_b64 v[20:21], v9 offset:2596
    ds_read_b32 v22, v9 offset:2604
    ds_read_b64 v[48:49], v9 offset:5188
    ds_read_b32 v50, v9 offset:5196
    ds_read_b64 v[52:53], v9 offset:7780
    ds_read_b32 v54, v9 offset:7788
    s_waitcnt lgkmcnt(0)
    v_add_f32 v16, v16, v20
    v_add_f32 v17, v17, v21
    v_add_f32 v18, v18, v22
    v_cvt_pk_bf16_f32 v24, v18, v18
    v_cvt_pk_bf16_f32 v32, v18, v17
    v_cvt_pk_bf16_f32 v25, v17, v17
    v_cvt_pk_bf16_f32 v33, v17, v17
    v_cvt_pk_bf16_f32 v26, v17, v16
    v_cvt_pk_bf16_f32 v34, v16, v16
    v_cvt_pk_bf16_f32 v27, v16, v16
    v_cvt_pk_bf16_f32 v35, v16, v16
    ds_write_b128 v11, v[24:27] offset:0
    ds_write_b128 v11, v[32:35] offset:4160
    v_add_f32 v48, v48, v52
    v_add_f32 v49, v49, v53
    v_add_f32 v50, v50, v54
    v_cvt_pk_bf16_f32 v56, v50, v50
    v_cvt_pk_bf16_f32 v64, v50, v49
    v_cvt_pk_bf16_f32 v57, v49, v49
    v_cvt_pk_bf16_f32 v65, v49, v49
    v_cvt_pk_bf16_f32 v58, v49, v48
    v_cvt_pk_bf16_f32 v66, v48, v48
    v_cvt_pk_bf16_f32 v59, v48, v48
    v_cvt_pk_bf16_f32 v67, v48, v48
    ds_write_b128 v11, v[56:59] offset:8320
    ds_write_b128 v11, v[64:67] offset:12480
    s_branch L_sgd
L_sg3:
    v_lshlrev_b32 v9, 3, v1
    v_add_u32 v9, 149772, v9
    v_lshlrev_b32 v11, 5, v1
    v_sub_u32 v11, 133088, v11
    ds_read_b64 v[16:17], v9 offset:4
    ds_read_b32 v18, v9 offset:12
    ds_read_b64 v[20:21], v9 offset:2596
    ds_read_b32 v22, v9 offset:2604
    ds_read_b64 v[48:49], v9 offset:5188
    ds_read_b32 v50, v9 offset:5196
    ds_read_b64 v[52:53], v9 offset:7780
    ds_read_b32 v54, v9 offset:7788
    s_waitcnt lgkmcnt(0)
    v_add_f32 v16, v16, v20
    v_add_f32 v17, v17, v21
    v_add_f32 v18, v18, v22
    v_cvt_pk_bf16_f32 v24, v18, v18
    v_cvt_pk_bf16_f32 v32, v18, v18
    v_cvt_pk_bf16_f32 v25, v18, v18
    v_cvt_pk_bf16_f32 v33, v18, v17
    v_cvt_pk_bf16_f32 v26, v17, v17
    v_cvt_pk_bf16_f32 v34, v17, v17
    v_cvt_pk_bf16_f32 v27, v17, v17
    v_cvt_pk_bf16_f32 v35, v17, v17
    v_cvt_pk_bf16_f32 v28, v17, v17
    v_cvt_pk_bf16_f32 v36, v17, v17
    v_cvt_pk_bf16_f32 v29, v17, v16
    v_cvt_pk_bf16_f32 v37, v16, v16
    v_cvt_pk_bf16_f32 v30, v16, v16
    v_cvt_pk_bf16_f32 v38, v16, v16
    v_cvt_pk_bf16_f32 v31, v16, v16
    v_cvt_pk_bf16_f32 v39, v16, v16
    ds_write_b128 v11, v[24:27] offset:0
    ds_write_b128 v11, v[28:31] offset:16
    ds_write_b128 v11, v[32:35] offset:4160
    ds_write_b128 v11, v[36:39] offset:4176
    v_add_f32 v48, v48, v52
    v_add_f32 v49, v49, v53
    v_add_f32 v50, v50, v54
    v_cvt_pk_bf16_f32 v56, v50, v50
    v_cvt_pk_bf16_f32 v64, v50, v50
    v_cvt_pk_bf16_f32 v57, v50, v50
    v_cvt_pk_bf16_f32 v65, v50, v49
    v_cvt_pk_bf16_f32 v58, v49, v49
    v_cvt_pk_bf16_f32 v66, v49, v49
    v_cvt_pk_bf16_f32 v59, v49, v49
    v_cvt_pk_bf16_f32 v67, v49, v49
    v_cvt_pk_bf16_f32 v60, v49, v49
    v_cvt_pk_bf16_f32 v68, v49, v49
    v_cvt_pk_bf16_f32 v61, v49, v48
    v_cvt_pk_bf16_f32 v69, v48, v48
    v_cvt_pk_bf16_f32 v62, v48, v48
    v_cvt_pk_bf16_f32 v70, v48, v48
    v_cvt_pk_bf16_f32 v63, v48, v48
    v_cvt_pk_bf16_f32 v71, v48, v48
    ds_write_b128 v11, v[56:59] offset:8320
    ds_write_b128 v11, v[60:63] offset:8336
    ds_write_b128 v11, v[64:67] offset:12480
    ds_write_b128 v11, v[68:71] offset:12496
L_sgd:
    s_mov_b64 exec, 1
    ds_add_u32 v3, v166 offset:28
    s_mov_b64 exec, -1
    s_mul_i32 s76, s101, 4352
    s_add_u32 s76, s76, 262144
    s_cmp_eq_u32 s97, 1
    s_cbranch_scc1 L_polled3
    v_and_b32 v6, 31, v1
    v_lshlrev_b32 v6, 2, v6
L_poll3:
    buffer_load_dword v7, v6, s[48:51], s76 offen sc1
    s_waitcnt vmcnt(0)
    v_xor_b32 v7, s99, v7
    v_cmp_lt_u32 vcc, 15, v7
    s_nop 0
    s_cbranch_vccz L_polled3
    s_sleep 8
    s_sub_u32 s83, s83, 16
    s_cbranch_scc0 L_poll3
    s_mov_b32 s83, 0
L_polled3:
L_wt12:
    ds_read_b32 v165, v3 offset:28
    s_waitcnt lgkmcnt(0)
    v_readfirstlane_b32 s93, v165
    s_nop 0
    s_cmp_ge_u32 s93, 4
    s_cbranch_scc1 L_wd12
    s_sleep 4
    s_sub_u32 s83, s83, 1
    s_cbranch_scc0 L_wt12
    s_mov_b32 s83, 0
L_wd12:
    s_mul_i32 s75, s96, 4608
    s_add_u32 s75, s75, 147712
    s_cmp_eq_u32 s97, 1
    s_cbranch_scc1 L_xpad
    s_add_u32 s75, s75, 512
    s_mov_b32 m0, s75
    s_add_u32 s74, s71, s96
    s_lshl_b32 s74, s74, 12
    s_add_u32 s74, s74, 6291456
    buffer_load_dwordx4 v2, s[48:51], s74 offen offset:0 sc1 lds
    buffer_load_dwordx4 v2, s[48:51], s74 offen offset:1024 sc1 lds
    buffer_load_dwordx4 v2, s[48:51], s74 offen offset:2048 sc1 lds
    buffer_load_dwordx4 v2, s[48:51], s74 offen offset:3072 sc1 lds
    s_branch L_xpad_d
L_xpad:
    v_mov_b32 v6, 0
    v_mov_b32 v7, 0
    v_lshlrev_b32 v8, 3, v1
    v_add_u32 v8, s75, v8
    ds_write_b64 v8, v[6:7]
L_xpad_d:
    s_waitcnt vmcnt(0)
    s_mov_b64 exec, 1
    ds_add_u32 v10, v166 offset:44
    s_mov_b64 exec, -1
    v_lshrrev_b32 v6, 1, v5
    v_lshlrev_b32 v6, 4, v6
    v_add_u32 v6, v6, v4
    v_and_b32 v7, 1, v5
    v_lshlrev_b32 v8, 3, v7
    v_sub_u32 v6, v6, v8
    v_sub_u32 v6, 2047, v6
    v_and_b32 v8, 1, v6
    v_sub_u32 v6, v6, v8
    v_lshlrev_b32 v6, 1, v6
    v_mul_u32_u24 v8, 4160, v8
    v_add_u32 v6, v6, v8
    s_mul_i32 s74, s96, 8320
    s_add_u32 s74, s74, 130880
    s_lshl_b32 s75, s97, 8
    s_sub_u32 s74, s74, s75
    v_add_u32 v12, s74, v6
    v_subrev_u32 v13, 512, v12
    v_subrev_u32 v14, 1024, v12
    v_subrev_u32 v15, 1536, v12
    v_subrev_u32 v16, 2048, v12
    v_subrev_u32 v17, 2560, v12
    v_subrev_u32 v18, 3072, v12
    v_subrev_u32 v19, 3584, v12
    v_lshrrev_b32 v6, 1, v5
    v_sub_u32 v6, v4, v6
    v_lshlrev_b32 v6, 5, v6
    v_lshl_add_u32 v6, v7, 4, v6
    s_mul_i32 s74, s96, 4608
    s_add_u32 s74, s74, 148032
    s_sub_u32 s74, s74, s75
    v_add_u32 v20, s74, v6
    ds_read2_b32 v[24:25], v12 offset0:48 offset1:49
    ds_read2_b32 v[26:27], v12 offset0:50 offset1:51
    ds_read2_b32 v[28:29], v13 offset0:48 offset1:49
    ds_read2_b32 v[30:31], v13 offset0:50 offset1:51
    ds_read2_b32 v[32:33], v14 offset0:48 offset1:49
    ds_read2_b32 v[34:35], v14 offset0:50 offset1:51
    ds_read2_b32 v[36:37], v15 offset0:48 offset1:49
    ds_read2_b32 v[38:39], v15 offset0:50 offset1:51
    ds_read2_b32 v[40:41], v16 offset0:48 offset1:49
    ds_read2_b32 v[42:43], v16 offset0:50 offset1:51
    ds_read2_b32 v[44:45], v17 offset0:48 offset1:49
    ds_read2_b32 v[46:47], v17 offset0:50 offset1:51
    ds_read2_b32 v[48:49], v18 offset0:48 offset1:49
    ds_read2_b32 v[50:51], v18 offset0:50 offset1:51
    ds_read2_b32 v[52:53], v19 offset0:48 offset1:49
    ds_read2_b32 v[54:55], v19 offset0:50 offset1:51
L_wt13:
    ds_read_b32 v165, v10 offset:44
    s_waitcnt lgkmcnt(0)
    v_readfirstlane_b32 s93, v165
    s_nop 0
    s_cmp_ge_u32 s93, 2
    s_cbranch_scc1 L_wd13
    s_sleep 4
    s_sub_u32 s83, s83, 1
    s_cbranch_scc0 L_wt13
    s_mov_b32 s83, 0
L_wd13:
    s_setprio 2
    ds_read_b128 v[56:59], v20 offset:192
    ds_read_b128 v[60:63], v20 offset:704
    ds_read_b128 v[64:67], v20 offset:1216
    ds_read_b128 v[68:71], v20 offset:1728
    ds_read_b128 v[72:75], v20 offset:2240
    ds_read_b128 v[76:79], v20 offset:2752
    ds_read_b128 v[80:83], v20 offset:3264
    ds_read_b128 v[84:87], v20 offset:3776
    s_waitcnt lgkmcnt(0)
    v_mfma_f32_16x16x32_bf16 v[148:151], v[52:55], v[56:59], 0
    ds_read2_b32 v[52:53], v19 offset0:32 offset1:33
    ds_read2_b32 v[54:55], v19 offset0:34 offset1:35
    ds_read_b128 v[116:119], v20 offset:3712
    v_mfma_f32_16x16x32_bf16 v[144:147], v[48:51], v[56:59], 0
    v_mfma_f32_16x16x32_bf16 v[148:151], v[48:51], v[60:63], v[148:151]
    ds_read2_b32 v[48:49], v18 offset0:32 offset1:33
    ds_read2_b32 v[50:51], v18 offset0:34 offset1:35
    ds_read_b128 v[112:115], v20 offset:3200
    v_mfma_f32_16x16x32_bf16 v[140:143], v[44:47], v[56:59], 0
    v_mfma_f32_16x16x32_bf16 v[144:147], v[44:47], v[60:63], v[144:147]
    v_mfma_f32_16x16x32_bf16 v[148:151], v[44:47], v[64:67], v[148:151]
    ds_read2_b32 v[44:45], v17 offset0:32 offset1:33
    ds_read2_b32 v[46:47], v17 offset0:34 offset1:35
    ds_read_b128 v[108:111], v20 offset:2688
    v_mfma_f32_16x16x32_bf16 v[136:139], v[40:43], v[56:59], 0
    v_mfma_f32_16x16x32_bf16 v[140:143], v[40:43], v[60:63], v[140:143]
    v_mfma_f32_16x16x32_bf16 v[144:147], v[40:43], v[64:67], v[144:147]
    v_mfma_f32_16x16x32_bf16 v[148:151], v[40:43], v[68:71], v[148:151]
    ds_read2_b32 v[40:41], v16 offset0:32 offset1:33
    ds_read2_b32 v[42:43], v16 offset0:34 offset1:35
    ds_read_b128 v[104:107], v20 offset:2176
    v_mfma_f32_16x16x32_bf16 v[132:135], v[36:39], v[56:59], 0
    v_mfma_f32_16x16x32_bf16 v[136:139], v[36:39], v[60:63], v[136:139]
    v_mfma_f32_16x16x32_bf16 v[140:143], v[36:39], v[64:67], v[140:143]
    v_mfma_f32_16x16x32_bf16 v[144:147], v[36:39], v[68:71], v[144:147]
    v_mfma_f32_16x16x32_bf16 v[148:151], v[36:39], v[72:75], v[148:151]
    ds_read2_b32 v[36:37], v15 offset0:32 offset1:33
    ds_read2_b32 v[38:39], v15 offset0:34 offset1:35
    ds_read_b128 v[100:103], v20 offset:1664
    v_mfma_f32_16x16x32_bf16 v[128:131], v[32:35], v[56:59], 0
    v_mfma_f32_16x16x32_bf16 v[132:135], v[32:35], v[60:63], v[132:135]
    v_mfma_f32_16x16x32_bf16 v[136:139], v[32:35], v[64:67], v[136:139]
    v_mfma_f32_16x16x32_bf16 v[140:143], v[32:35], v[68:71], v[140:143]
    v_mfma_f32_16x16x32_bf16 v[144:147], v[32:35], v[72:75], v[144:147]
    v_mfma_f32_16x16x32_bf16 v[148:151], v[32:35], v[76:79], v[148:151]
    ds_read2_b32 v[32:33], v14 offset0:32 offset1:33
    ds_read2_b32 v[34:35], v14 offset0:34 offset1:35
    ds_read_b128 v[96:99], v20 offset:1152
    v_mfma_f32_16x16x32_bf16 v[124:127], v[28:31], v[56:59], 0
    v_mfma_f32_16x16x32_bf16 v[128:131], v[28:31], v[60:63], v[128:131]
    v_mfma_f32_16x16x32_bf16 v[132:135], v[28:31], v[64:67], v[132:135]
    v_mfma_f32_16x16x32_bf16 v[136:139], v[28:31], v[68:71], v[136:139]
    v_mfma_f32_16x16x32_bf16 v[140:143], v[28:31], v[72:75], v[140:143]
    v_mfma_f32_16x16x32_bf16 v[144:147], v[28:31], v[76:79], v[144:147]
    v_mfma_f32_16x16x32_bf16 v[148:151], v[28:31], v[80:83], v[148:151]
    ds_read2_b32 v[28:29], v13 offset0:32 offset1:33
    ds_read2_b32 v[30:31], v13 offset0:34 offset1:35
    ds_read_b128 v[92:95], v20 offset:640
    v_mfma_f32_16x16x32_bf16 v[120:123], v[24:27], v[56:59], 0
    v_mfma_f32_16x16x32_bf16 v[124:127], v[24:27], v[60:63], v[124:127]
    v_mfma_f32_16x16x32_bf16 v[128:131], v[24:27], v[64:67], v[128:131]
    v_mfma_f32_16x16x32_bf16 v[132:135], v[24:27], v[68:71], v[132:135]
    v_mfma_f32_16x16x32_bf16 v[136:139], v[24:27], v[72:75], v[136:139]
    v_mfma_f32_16x16x32_bf16 v[140:143], v[24:27], v[76:79], v[140:143]
    v_mfma_f32_16x16x32_bf16 v[144:147], v[24:27], v[80:83], v[144:147]
    v_mfma_f32_16x16x32_bf16 v[148:151], v[24:27], v[84:87], v[148:151]
    ds_read2_b32 v[24:25], v12 offset0:32 offset1:33
    ds_read2_b32 v[26:27], v12 offset0:34 offset1:35
    ds_read_b128 v[88:91], v20 offset:128
    s_waitcnt lgkmcnt(0)
    v_mfma_f32_16x16x32_bf16 v[148:151], v[52:55], v[88:91], v[148:151]
    ds_read2_b32 v[52:53], v19 offset0:16 offset1:17
    ds_read2_b32 v[54:55], v19 offset0:18 offset1:19
    ds_read_b128 v[84:87], v20 offset:3648
    v_mfma_f32_16x16x32_bf16 v[144:147], v[48:51], v[88:91], v[144:147]
    v_mfma_f32_16x16x32_bf16 v[148:151], v[48:51], v[92:95], v[148:151]
    ds_read2_b32 v[48:49], v18 offset0:16 offset1:17
    ds_read2_b32 v[50:51], v18 offset0:18 offset1:19
    ds_read_b128 v[80:83], v20 offset:3136
    v_mfma_f32_16x16x32_bf16 v[140:143], v[44:47], v[88:91], v[140:143]
    v_mfma_f32_16x16x32_bf16 v[144:147], v[44:47], v[92:95], v[144:147]
    v_mfma_f32_16x16x32_bf16 v[148:151], v[44:47], v[96:99], v[148:151]
    ds_read2_b32 v[44:45], v17 offset0:16 offset1:17
    ds_read2_b32 v[46:47], v17 offset0:18 offset1:19
    ds_read_b128 v[76:79], v20 offset:2624
    v_mfma_f32_16x16x32_bf16 v[136:139], v[40:43], v[88:91], v[136:139]
    v_mfma_f32_16x16x32_bf16 v[140:143], v[40:43], v[92:95], v[140:143]
    v_mfma_f32_16x16x32_bf16 v[144:147], v[40:43], v[96:99], v[144:147]
    v_mfma_f32_16x16x32_bf16 v[148:151], v[40:43], v[100:103], v[148:151]
    ds_read2_b32 v[40:41], v16 offset0:16 offset1:17
    ds_read2_b32 v[42:43], v16 offset0:18 offset1:19
    ds_read_b128 v[72:75], v20 offset:2112
    v_mfma_f32_16x16x32_bf16 v[132:135], v[36:39], v[88:91], v[132:135]
    v_mfma_f32_16x16x32_bf16 v[136:139], v[36:39], v[92:95], v[136:139]
    v_mfma_f32_16x16x32_bf16 v[140:143], v[36:39], v[96:99], v[140:143]
    v_mfma_f32_16x16x32_bf16 v[144:147], v[36:39], v[100:103], v[144:147]
    v_mfma_f32_16x16x32_bf16 v[148:151], v[36:39], v[104:107], v[148:151]
    ds_read2_b32 v[36:37], v15 offset0:16 offset1:17
    ds_read2_b32 v[38:39], v15 offset0:18 offset1:19
    ds_read_b128 v[68:71], v20 offset:1600
    v_mfma_f32_16x16x32_bf16 v[128:131], v[32:35], v[88:91], v[128:131]
    v_mfma_f32_16x16x32_bf16 v[132:135], v[32:35], v[92:95], v[132:135]
    v_mfma_f32_16x16x32_bf16 v[136:139], v[32:35], v[96:99], v[136:139]
    v_mfma_f32_16x16x32_bf16 v[140:143], v[32:35], v[100:103], v[140:143]
    v_mfma_f32_16x16x32_bf16 v[144:147], v[32:35], v[104:107], v[144:147]
    v_mfma_f32_16x16x32_bf16 v[148:151], v[32:35], v[108:111], v[148:151]
    ds_read2_b32 v[32:33], v14 offset0:16 offset1:17
    ds_read2_b32 v[34:35], v14 offset0:18 offset1:19
    ds_read_b128 v[64:67], v20 offset:1088
    v_mfma_f32_16x16x32_bf16 v[124:127], v[28:31], v[88:91], v[124:127]
    v_mfma_f32_16x16x32_bf16 v[128:131], v[28:31], v[92:95], v[128:131]
    v_mfma_f32_16x16x32_bf16 v[132:135], v[28:31], v[96:99], v[132:135]
    v_mfma_f32_16x16x32_bf16 v[136:139], v[28:31], v[100:103], v[136:139]
    v_mfma_f32_16x16x32_bf16 v[140:143], v[28:31], v[104:107], v[140:143]
    v_mfma_f32_16x16x32_bf16 v[144:147], v[28:31], v[108:111], v[144:147]
    v_mfma_f32_16x16x32_bf16 v[148:151], v[28:31], v[112:115], v[148:151]
    ds_read2_b32 v[28:29], v13 offset0:16 offset1:17
    ds_read2_b32 v[30:31], v13 offset0:18 offset1:19
    ds_read_b128 v[60:63], v20 offset:576
    v_mfma_f32_16x16x32_bf16 v[120:123], v[24:27], v[88:91], v[120:123]
    v_mfma_f32_16x16x32_bf16 v[124:127], v[24:27], v[92:95], v[124:127]
    v_mfma_f32_16x16x32_bf16 v[128:131], v[24:27], v[96:99], v[128:131]
    v_mfma_f32_16x16x32_bf16 v[132:135], v[24:27], v[100:103], v[132:135]
    v_mfma_f32_16x16x32_bf16 v[136:139], v[24:27], v[104:107], v[136:139]
    v_mfma_f32_16x16x32_bf16 v[140:143], v[24:27], v[108:111], v[140:143]
    v_mfma_f32_16x16x32_bf16 v[144:147], v[24:27], v[112:115], v[144:147]
    v_mfma_f32_16x16x32_bf16 v[148:151], v[24:27], v[116:119], v[148:151]
    ds_read2_b32 v[24:25], v12 offset0:16 offset1:17
    ds_read2_b32 v[26:27], v12 offset0:18 offset1:19
    ds_read_b128 v[56:59], v20 offset:64
    s_waitcnt lgkmcnt(0)
    v_mfma_f32_16x16x32_bf16 v[148:151], v[52:55], v[56:59], v[148:151]
    ds_read2_b32 v[52:53], v19 offset0:0 offset1:1
    ds_read2_b32 v[54:55], v19 offset0:2 offset1:3
    ds_read_b128 v[116:119], v20 offset:3584
    v_mfma_f32_16x16x32_bf16 v[144:147], v[48:51], v[56:59], v[144:147]
    v_mfma_f32_16x16x32_bf16 v[148:151], v[48:51], v[60:63], v[148:151]
    ds_read2_b32 v[48:49], v18 offset0:0 offset1:1
    ds_read2_b32 v[50:51], v18 offset0:2 offset1:3
    ds_read_b128 v[112:115], v20 offset:3072
    v_mfma_f32_16x16x32_bf16 v[140:143], v[44:47], v[56:59], v[140:143]
    v_mfma_f32_16x16x32_bf16 v[144:147], v[44:47], v[60:63], v[144:147]
    v_mfma_f32_16x16x32_bf16 v[148:151], v[44:47], v[64:67], v[148:151]
    ds_read2_b32 v[44:45], v17 offset0:0 offset1:1
    ds_read2_b32 v[46:47], v17 offset0:2 offset1:3
    ds_read_b128 v[108:111], v20 offset:2560
    v_mfma_f32_16x16x32_bf16 v[136:139], v[40:43], v[56:59], v[136:139]
    v_mfma_f32_16x16x32_bf16 v[140:143], v[40:43], v[60:63], v[140:143]
    v_mfma_f32_16x16x32_bf16 v[144:147], v[40:43], v[64:67], v[144:147]
    v_mfma_f32_16x16x32_bf16 v[148:151], v[40:43], v[68:71], v[148:151]
    ds_read2_b32 v[40:41], v16 offset0:0 offset1:1
    ds_read2_b32 v[42:43], v16 offset0:2 offset1:3
    ds_read_b128 v[104:107], v20 offset:2048
    v_mfma_f32_16x16x32_bf16 v[132:135], v[36:39], v[56:59], v[132:135]
    v_mfma_f32_16x16x32_bf16 v[136:139], v[36:39], v[60:63], v[136:139]
    v_mfma_f32_16x16x32_bf16 v[140:143], v[36:39], v[64:67], v[140:143]
    v_mfma_f32_16x16x32_bf16 v[144:147], v[36:39], v[68:71], v[144:147]
    v_mfma_f32_16x16x32_bf16 v[148:151], v[36:39], v[72:75], v[148:151]
    ds_read2_b32 v[36:37], v15 offset0:0 offset1:1
    ds_read2_b32 v[38:39], v15 offset0:2 offset1:3
    ds_read_b128 v[100:103], v20 offset:1536
    v_mfma_f32_16x16x32_bf16 v[128:131], v[32:35], v[56:59], v[128:131]
    v_mfma_f32_16x16x32_bf16 v[132:135], v[32:35], v[60:63], v[132:135]
    v_mfma_f32_16x16x32_bf16 v[136:139], v[32:35], v[64:67], v[136:139]
    v_mfma_f32_16x16x32_bf16 v[140:143], v[32:35], v[68:71], v[140:143]
    v_mfma_f32_16x16x32_bf16 v[144:147], v[32:35], v[72:75], v[144:147]
    v_mfma_f32_16x16x32_bf16 v[148:151], v[32:35], v[76:79], v[148:151]
    ds_read2_b32 v[32:33], v14 offset0:0 offset1:1
    ds_read2_b32 v[34:35], v14 offset0:2 offset1:3
    ds_read_b128 v[96:99], v20 offset:1024
    v_mfma_f32_16x16x32_bf16 v[124:127], v[28:31], v[56:59], v[124:127]
    v_mfma_f32_16x16x32_bf16 v[128:131], v[28:31], v[60:63], v[128:131]
    v_mfma_f32_16x16x32_bf16 v[132:135], v[28:31], v[64:67], v[132:135]
    v_mfma_f32_16x16x32_bf16 v[136:139], v[28:31], v[68:71], v[136:139]
    v_mfma_f32_16x16x32_bf16 v[140:143], v[28:31], v[72:75], v[140:143]
    v_mfma_f32_16x16x32_bf16 v[144:147], v[28:31], v[76:79], v[144:147]
    v_mfma_f32_16x16x32_bf16 v[148:151], v[28:31], v[80:83], v[148:151]
    ds_read2_b32 v[28:29], v13 offset0:0 offset1:1
    ds_read2_b32 v[30:31], v13 offset0:2 offset1:3
    ds_read_b128 v[92:95], v20 offset:512
    v_mfma_f32_16x16x32_bf16 v[120:123], v[24:27], v[56:59], v[120:123]
    v_mfma_f32_16x16x32_bf16 v[124:127], v[24:27], v[60:63], v[124:127]
    v_mfma_f32_16x16x32_bf16 v[128:131], v[24:27], v[64:67], v[128:131]
    v_mfma_f32_16x16x32_bf16 v[132:135], v[24:27], v[68:71], v[132:135]
    v_mfma_f32_16x16x32_bf16 v[136:139], v[24:27], v[72:75], v[136:139]
    v_mfma_f32_16x16x32_bf16 v[140:143], v[24:27], v[76:79], v[140:143]
    v_mfma_f32_16x16x32_bf16 v[144:147], v[24:27], v[80:83], v[144:147]
    v_mfma_f32_16x16x32_bf16 v[148:151], v[24:27], v[84:87], v[148:151]
    ds_read2_b32 v[24:25], v12 offset0:0 offset1:1
    ds_read2_b32 v[26:27], v12 offset0:2 offset1:3
    ds_read_b128 v[88:91], v20 offset:0
    s_waitcnt lgkmcnt(0)
    v_mfma_f32_16x16x32_bf16 v[148:151], v[52:55], v[88:91], v[148:151]
    v_mfma_f32_16x16x32_bf16 v[144:147], v[48:51], v[88:91], v[144:147]
    v_mfma_f32_16x16x32_bf16 v[148:151], v[48:51], v[92:95], v[148:151]
    v_mfma_f32_16x16x32_bf16 v[140:143], v[44:47], v[88:91], v[140:143]
    v_mfma_f32_16x16x32_bf16 v[144:147], v[44:47], v[92:95], v[144:147]
    v_mfma_f32_16x16x32_bf16 v[148:151], v[44:47], v[96:99], v[148:151]
    v_mfma_f32_16x16x32_bf16 v[136:139], v[40:43], v[88:91], v[136:139]
    v_mfma_f32_16x16x32_bf16 v[140:143], v[40:43], v[92:95], v[140:143]
    v_mfma_f32_16x16x32_bf16 v[144:147], v[40:43], v[96:99], v[144:147]
    v_mfma_f32_16x16x32_bf16 v[148:151], v[40:43], v[100:103], v[148:151]
    v_mfma_f32_16x16x32_bf16 v[132:135], v[36:39], v[88:91], v[132:135]
    v_mfma_f32_16x16x32_bf16 v[136:139], v[36:39], v[92:95], v[136:139]
    v_mfma_f32_16x16x32_bf16 v[140:143], v[36:39], v[96:99], v[140:143]
    v_mfma_f32_16x16x32_bf16 v[144:147], v[36:39], v[100:103], v[144:147]
    v_mfma_f32_16x16x32_bf16 v[148:151], v[36:39], v[104:107], v[148:151]
    v_mfma_f32_16x16x32_bf16 v[128:131], v[32:35], v[88:91], v[128:131]
    v_mfma_f32_16x16x32_bf16 v[132:135], v[32:35], v[92:95], v[132:135]
    v_mfma_f32_16x16x32_bf16 v[136:139], v[32:35], v[96:99], v[136:139]
    v_mfma_f32_16x16x32_bf16 v[140:143], v[32:35], v[100:103], v[140:143]
    v_mfma_f32_16x16x32_bf16 v[144:147], v[32:35], v[104:107], v[144:147]
    v_mfma_f32_16x16x32_bf16 v[148:151], v[32:35], v[108:111], v[148:151]
    v_mfma_f32_16x16x32_bf16 v[124:127], v[28:31], v[88:91], v[124:127]
    v_mfma_f32_16x16x32_bf16 v[128:131], v[28:31], v[92:95], v[128:131]
    v_mfma_f32_16x16x32_bf16 v[132:135], v[28:31], v[96:99], v[132:135]
    v_mfma_f32_16x16x32_bf16 v[136:139], v[28:31], v[100:103], v[136:139]
    v_mfma_f32_16x16x32_bf16 v[140:143], v[28:31], v[104:107], v[140:143]
    v_mfma_f32_16x16x32_bf16 v[144:147], v[28:31], v[108:111], v[144:147]
    v_mfma_f32_16x16x32_bf16 v[148:151], v[28:31], v[112:115], v[148:151]
    v_mfma_f32_16x16x32_bf16 v[120:123], v[24:27], v[88:91], v[120:123]
    v_mfma_f32_16x16x32_bf16 v[124:127], v[24:27], v[92:95], v[124:127]
    v_mfma_f32_16x16x32_bf16 v[128:131], v[24:27], v[96:99], v[128:131]
    v_mfma_f32_16x16x32_bf16 v[132:135], v[24:27], v[100:103], v[132:135]
    v_mfma_f32_16x16x32_bf16 v[136:139], v[24:27], v[104:107], v[136:139]
    v_mfma_f32_16x16x32_bf16 v[140:143], v[24:27], v[108:111], v[140:143]
    v_mfma_f32_16x16x32_bf16 v[144:147], v[24:27], v[112:115], v[144:147]
    v_mfma_f32_16x16x32_bf16 v[148:151], v[24:27], v[116:119], v[148:151]
    s_setprio 3
    s_mov_b64 exec, 1
    ds_add_u32 v10, v166 offset:52
    s_mov_b64 exec, -1
    s_cmp_eq_u32 s97, 0
    s_cbranch_scc1 L_noswap
    s_nop 7
    v_swap_b32 v120, v136
    v_swap_b32 v121, v137
    v_swap_b32 v122, v138
    v_swap_b32 v123, v139
    v_swap_b32 v124, v140
    v_swap_b32 v125, v141
    v_swap_b32 v126, v142
    v_swap_b32 v127, v143
    v_swap_b32 v128, v144
    v_swap_b32 v129, v145
    v_swap_b32 v130, v146
    v_swap_b32 v131, v147
    v_swap_b32 v132, v148
    v_swap_b32 v133, v149
    v_swap_b32 v134, v150
    v_swap_b32 v135, v151
L_noswap:
    s_mul_i32 s74, s96, 8320
    s_add_u32 s74, s74, 131072
    s_lshl_b32 s75, s97, 12
    s_add_u32 s76, s74, s75
    s_xor_b32 s75, s75, 4096
    s_add_u32 s74, s74, s75
    v_add_u32 v6, s76, v2
    v_add_u32 v7, s74, v2
L_wt14:
    ds_read_b32 v165, v10 offset:52
    s_waitcnt lgkmcnt(0)
    v_readfirstlane_b32 s93, v165
    s_nop 0
    s_cmp_ge_u32 s93, 2
    s_cbranch_scc1 L_wd14
    s_sleep 3
    s_sub_u32 s83, s83, 1
    s_cbranch_scc0 L_wt14
    s_mov_b32 s83, 0
L_wd14:
    ds_write_b128 v6, v[136:139] offset:0
    ds_write_b128 v6, v[140:143] offset:1024
    ds_write_b128 v6, v[144:147] offset:2048
    ds_write_b128 v6, v[148:151] offset:3072
    s_mov_b64 exec, 1
    ds_add_u32 v10, v166 offset:60
    s_mov_b64 exec, -1
    v_lshlrev_b32 v8, 5, v4
    v_lshl_add_u32 v8, v5, 3, v8
    s_lshl_b32 s75, s97, 11
    v_add_u32 v8, s75, v8
    s_mul_i32 s74, s96, 4608
    s_add_u32 s74, s74, 148224
    v_add_u32 v9, s74, v8
    s_add_u32 s74, s71, s96
    s_lshl_b32 s74, s74, 12
    s_add_u32 s74, s74, 4194304
    s_lshl_b32 s75, s96, 4
    s_lshr_b32 s75, s73, s75
    s_lshl_b32 s75, s75, 16
    s_mov_b32 s76, 0xfffefffe
L_wt15:
    ds_read_b32 v165, v3 offset:32
    s_waitcnt lgkmcnt(0)
    v_readfirstlane_b32 s93, v165
    s_nop 0
    s_cmp_ge_u32 s93, 1
    s_cbranch_scc1 L_wd15
    s_sleep 1
    s_sub_u32 s83, s83, 1
    s_cbranch_scc0 L_wt15
    s_mov_b32 s83, 0
L_wd15:
L_wt16:
    ds_read_b32 v165, v10 offset:60
    s_waitcnt lgkmcnt(0)
    v_readfirstlane_b32 s93, v165
    s_nop 0
    s_cmp_ge_u32 s93, 2
    s_cbranch_scc1 L_wd16
    s_sleep 3
    s_sub_u32 s83, s83, 1
    s_cbranch_scc0 L_wt16
    s_mov_b32 s83, 0
L_wd16:
    ds_read_b128 v[136:139], v7 offset:0
    ds_read_b64 v[24:25], v9 offset:0
    ds_read_b128 v[140:143], v7 offset:1024
    ds_read_b64 v[26:27], v9 offset:512
    ds_read_b128 v[144:147], v7 offset:2048
    ds_read_b64 v[28:29], v9 offset:1024
    ds_read_b128 v[148:151], v7 offset:3072
    ds_read_b64 v[30:31], v9 offset:1536
    s_mov_b64 exec, 1
    ds_add_u32 v3, v166 offset:68
    s_mov_b64 exec, -1
    s_waitcnt lgkmcnt(7)
    v_add_f32 v120, v120, v136
    v_add_f32 v121, v121, v137
    v_add_f32 v122, v122, v138
    v_add_f32 v123, v123, v139
    v_lshlrev_b32 v41, 16, v24
    v_and_b32 v42, 0xffff0000, v24
    v_fmac_f32 v120, s75, v41
    v_fmac_f32 v121, s75, v42
    v_cvt_pk_bf16_f32 v24, v120, v121
    v_pk_min_u16 v24, v24, s76
    v_lshlrev_b32 v41, 16, v25
    v_and_b32 v42, 0xffff0000, v25
    v_fmac_f32 v122, s75, v41
    v_fmac_f32 v123, s75, v42
    v_cvt_pk_bf16_f32 v25, v122, v123
    v_pk_min_u16 v25, v25, s76
    buffer_store_dwordx2 v[24:25], v8, s[48:51], s74 offen offset:0 sc1
    s_waitcnt lgkmcnt(5)
    v_add_f32 v124, v124, v140
    v_add_f32 v125, v125, v141
    v_add_f32 v126, v126, v142
    v_add_f32 v127, v127, v143
    v_lshlrev_b32 v41, 16, v26
    v_and_b32 v42, 0xffff0000, v26
    v_fmac_f32 v124, s75, v41
    v_fmac_f32 v125, s75, v42
    v_cvt_pk_bf16_f32 v26, v124, v125
    v_pk_min_u16 v26, v26, s76
    v_lshlrev_b32 v41, 16, v27
    v_and_b32 v42, 0xffff0000, v27
    v_fmac_f32 v126, s75, v41
    v_fmac_f32 v127, s75, v42
    v_cvt_pk_bf16_f32 v27, v126, v127
    v_pk_min_u16 v27, v27, s76
    buffer_store_dwordx2 v[26:27], v8, s[48:51], s74 offen offset:512 sc1
    s_waitcnt lgkmcnt(3)
    v_add_f32 v128, v128, v144
    v_add_f32 v129, v129, v145
    v_add_f32 v130, v130, v146
    v_add_f32 v131, v131, v147
    v_lshlrev_b32 v41, 16, v28
    v_and_b32 v42, 0xffff0000, v28
    v_fmac_f32 v128, s75, v41
    v_fmac_f32 v129, s75, v42
    v_cvt_pk_bf16_f32 v28, v128, v129
    v_pk_min_u16 v28, v28, s76
    v_lshlrev_b32 v41, 16, v29
    v_and_b32 v42, 0xffff0000, v29
    v_fmac_f32 v130, s75, v41
    v_fmac_f32 v131, s75, v42
    v_cvt_pk_bf16_f32 v29, v130, v131
    v_pk_min_u16 v29, v29, s76
    buffer_store_dwordx2 v[28:29], v8, s[48:51], s74 offen offset:1024 sc1
    s_waitcnt lgkmcnt(1)
    v_add_f32 v132, v132, v148
    v_add_f32 v133, v133, v149
    v_add_f32 v134, v134, v150
    v_add_f32 v135, v135, v151
    v_lshlrev_b32 v41, 16, v30
    v_and_b32 v42, 0xffff0000, v30
    v_fmac_f32 v132, s75, v41
    v_fmac_f32 v133, s75, v42
    v_cvt_pk_bf16_f32 v30, v132, v133
    v_pk_min_u16 v30, v30, s76
    v_lshlrev_b32 v41, 16, v31
    v_and_b32 v42, 0xffff0000, v31
    v_fmac_f32 v134, s75, v41
    v_fmac_f32 v135, s75, v42
    v_cvt_pk_bf16_f32 v31, v134, v135
    v_pk_min_u16 v31, v31, s76
    buffer_store_dwordx2 v[30:31], v8, s[48:51], s74 offen offset:1536 sc1
    v_lshrrev_b32 v6, 2, v1
    v_lshlrev_b32 v6, 10, v6
    v_and_b32 v7, 3, v1
    v_lshl_add_u32 v6, v7, 4, v6
    s_lshr_b32 s74, s70, 1
    s_lshl_b32 s74, s74, 8
    s_lshl_b32 s75, s68, 6
    s_add_u32 s74, s74, s75
    s_mul_i32 s76, s68, 6144
    s_add_u32 s76, s76, 131072
    v_bfe_u32 v8, v1, 2, 2
    v_lshrrev_b32 v9, 5, v1
    v_lshl_add_u32 v8, v9, 2, v8
    v_lshlrev_b32 v8, 6, v8
    v_bfe_u32 v9, v1, 4, 1
    v_lshl_add_u32 v8, v9, 5, v8
    v_lshl_add_u32 v8, v7, 3, v8
    v_add_u32 v8, s76, v8
    s_waitcnt vmcnt(0)
L_wt17:
    ds_read_b32 v165, v3 offset:68
    s_waitcnt lgkmcnt(0)
    v_readfirstlane_b32 s93, v165
    s_nop 0
    s_cmp_ge_u32 s93, 4
    s_cbranch_scc1 L_wd17
    s_sleep 4
    s_sub_u32 s83, s83, 1
    s_cbranch_scc0 L_wt17
    s_mov_b32 s83, 0
L_wd17:
    s_add_u32 s77, s76, 0
    s_mov_b32 m0, s77
    s_nop 0
    buffer_load_dwordx4 v6, s[64:67], s74 offen lds
    s_add_u32 s74, s74, 16384
    s_add_u32 s77, s76, 1024
    s_mov_b32 m0, s77
    s_nop 0
    buffer_load_dwordx4 v6, s[64:67], s74 offen lds
    s_add_u32 s74, s74, 16384
    s_add_u32 s77, s76, 2048
    s_mov_b32 m0, s77
    s_nop 0
    buffer_load_dwordx4 v6, s[64:67], s74 offen lds
    s_add_u32 s74, s74, 16384
    s_add_u32 s77, s76, 3072
    s_mov_b32 m0, s77
    s_nop 0
    buffer_load_dwordx4 v6, s[64:67], s74 offen lds
    s_add_u32 s74, s74, 16384
    s_add_u32 s77, s76, 4096
    s_mov_b32 m0, s77
    s_nop 0
    buffer_load_dwordx4 v6, s[64:67], s74 offen lds
    s_add_u32 s74, s74, 16384
    s_add_u32 s77, s76, 5120
    s_mov_b32 m0, s77
    s_nop 0
    buffer_load_dwordx4 v6, s[64:67], s74 offen lds
    s_add_u32 s74, s74, 16384
    s_waitcnt vmcnt(5)
    ds_read_b64_tr_b16 v[36:37], v8 offset:0
    ds_read_b64_tr_b16 v[38:39], v8 offset:512
    s_waitcnt lgkmcnt(0)
    s_add_u32 s77, s76, 0
    s_mov_b32 m0, s77
    s_nop 0
    buffer_load_dwordx4 v6, s[64:67], s74 offen lds
    s_add_u32 s74, s74, 16384
    s_waitcnt vmcnt(5)
    ds_read_b64_tr_b16 v[40:41], v8 offset:1024
    ds_read_b64_tr_b16 v[42:43], v8 offset:1536
    s_waitcnt lgkmcnt(0)
    s_add_u32 s77, s76, 1024
    s_mov_b32 m0, s77
    s_nop 0
    buffer_load_dwordx4 v6, s[64:67], s74 offen lds
    s_add_u32 s74, s74, 16384
    s_waitcnt vmcnt(5)
    ds_read_b64_tr_b16 v[44:45], v8 offset:2048
    ds_read_b64_tr_b16 v[46:47], v8 offset:2560
    s_waitcnt lgkmcnt(0)
    s_add_u32 s77, s76, 2048
    s_mov_b32 m0, s77
    s_nop 0
    buffer_load_dwordx4 v6, s[64:67], s74 offen lds
    s_add_u32 s74, s74, 16384
    s_waitcnt vmcnt(5)
    ds_read_b64_tr_b16 v[48:49], v8 offset:3072
    ds_read_b64_tr_b16 v[50:51], v8 offset:3584
    s_waitcnt lgkmcnt(0)
    s_add_u32 s77, s76, 3072
    s_mov_b32 m0, s77
    s_nop 0
    buffer_load_dwordx4 v6, s[64:67], s74 offen lds
    s_add_u32 s74, s74, 16384
    s_waitcnt vmcnt(5)
    ds_read_b64_tr_b16 v[52:53], v8 offset:4096
    ds_read_b64_tr_b16 v[54:55], v8 offset:4608
    s_waitcnt lgkmcnt(0)
    s_add_u32 s77, s76, 4096
    s_mov_b32 m0, s77
    s_nop 0
    buffer_load_dwordx4 v6, s[64:67], s74 offen lds
    s_add_u32 s74, s74, 16384
    s_waitcnt vmcnt(5)
    ds_read_b64_tr_b16 v[56:57], v8 offset:5120
    ds_read_b64_tr_b16 v[58:59], v8 offset:5632
    s_waitcnt lgkmcnt(0)
    s_add_u32 s77, s76, 5120
    s_mov_b32 m0, s77
    s_nop 0
    buffer_load_dwordx4 v6, s[64:67], s74 offen lds
    s_add_u32 s74, s74, 16384
    s_waitcnt vmcnt(5)
    ds_read_b64_tr_b16 v[60:61], v8 offset:0
    ds_read_b64_tr_b16 v[62:63], v8 offset:512
    s_waitcnt lgkmcnt(0)
    s_add_u32 s77, s76, 0
    s_mov_b32 m0, s77
    s_nop 0
    buffer_load_dwordx4 v6, s[64:67], s74 offen lds
    s_add_u32 s74, s74, 16384
    s_waitcnt vmcnt(5)
    ds_read_b64_tr_b16 v[64:65], v8 offset:1024
    ds_read_b64_tr_b16 v[66:67], v8 offset:1536
    s_waitcnt lgkmcnt(0)
    s_add_u32 s77, s76, 1024
    s_mov_b32 m0, s77
    s_nop 0
    buffer_load_dwordx4 v6, s[64:67], s74 offen lds
    s_add_u32 s74, s74, 16384
    s_waitcnt vmcnt(5)
    ds_read_b64_tr_b16 v[68:69], v8 offset:2048
    ds_read_b64_tr_b16 v[70:71], v8 offset:2560
    s_waitcnt lgkmcnt(0)
    s_add_u32 s77, s76, 2048
    s_mov_b32 m0, s77
    s_nop 0
    buffer_load_dwordx4 v6, s[64:67], s74 offen lds
    s_add_u32 s74, s74, 16384
    s_waitcnt vmcnt(5)
    ds_read_b64_tr_b16 v[72:73], v8 offset:3072
    ds_read_b64_tr_b16 v[74:75], v8 offset:3584
    s_waitcnt lgkmcnt(0)
    s_add_u32 s77, s76, 3072
    s_mov_b32 m0, s77
    s_nop 0
    buffer_load_dwordx4 v6, s[64:67], s74 offen lds
    s_add_u32 s74, s74, 16384
    s_waitcnt vmcnt(5)
    ds_read_b64_tr_b16 v[76:77], v8 offset:4096
    ds_read_b64_tr_b16 v[78:79], v8 offset:4608
    s_waitcnt lgkmcnt(0)
    s_add_u32 s77, s76, 4096
    s_mov_b32 m0, s77
    s_nop 0
    buffer_load_dwordx4 v6, s[64:67], s74 offen lds
    s_add_u32 s74, s74, 16384
    s_waitcnt vmcnt(5)
    ds_read_b64_tr_b16 v[80:81], v8 offset:5120
    ds_read_b64_tr_b16 v[82:83], v8 offset:5632
    s_waitcnt lgkmcnt(0)
    s_add_u32 s77, s76, 5120
    s_mov_b32 m0, s77
    s_nop 0
    buffer_load_dwordx4 v6, s[64:67], s74 offen lds
    s_add_u32 s74, s74, 16384
    s_waitcnt vmcnt(5)
    ds_read_b64_tr_b16 v[84:85], v8 offset:0
    ds_read_b64_tr_b16 v[86:87], v8 offset:512
    s_waitcnt lgkmcnt(0)
    s_add_u32 s77, s76, 0
    s_mov_b32 m0, s77
    s_nop 0
    buffer_load_dwordx4 v6, s[64:67], s74 offen lds
    s_add_u32 s74, s74, 16384
    s_waitcnt vmcnt(5)
    ds_read_b64_tr_b16 v[88:89], v8 offset:1024
    ds_read_b64_tr_b16 v[90:91], v8 offset:1536
    s_waitcnt lgkmcnt(0)
    s_add_u32 s77, s76, 1024
    s_mov_b32 m0, s77
    s_nop 0
    buffer_load_dwordx4 v6, s[64:67], s74 offen lds
    s_add_u32 s74, s74, 16384
    s_waitcnt vmcnt(5)
    ds_read_b64_tr_b16 v[92:93], v8 offset:2048
    ds_read_b64_tr_b16 v[94:95], v8 offset:2560
    s_waitcnt lgkmcnt(0)
    s_add_u32 s77, s76, 2048
    s_mov_b32 m0, s77
    s_nop 0
    buffer_load_dwordx4 v6, s[64:67], s74 offen lds
    s_add_u32 s74, s74, 16384
    s_waitcnt vmcnt(5)
    ds_read_b64_tr_b16 v[96:97], v8 offset:3072
    ds_read_b64_tr_b16 v[98:99], v8 offset:3584
    s_waitcnt lgkmcnt(0)
    s_add_u32 s77, s76, 3072
    s_mov_b32 m0, s77
    s_nop 0
    buffer_load_dwordx4 v6, s[64:67], s74 offen lds
    s_add_u32 s74, s74, 16384
    s_waitcnt vmcnt(5)
    ds_read_b64_tr_b16 v[100:101], v8 offset:4096
    ds_read_b64_tr_b16 v[102:103], v8 offset:4608
    s_waitcnt lgkmcnt(0)
    s_add_u32 s77, s76, 4096
    s_mov_b32 m0, s77
    s_nop 0
    buffer_load_dwordx4 v6, s[64:67], s74 offen lds
    s_add_u32 s74, s74, 16384
    s_waitcnt vmcnt(5)
    ds_read_b64_tr_b16 v[104:105], v8 offset:5120
    ds_read_b64_tr_b16 v[106:107], v8 offset:5632
    s_waitcnt lgkmcnt(0)
    s_add_u32 s77, s76, 5120
    s_mov_b32 m0, s77
    s_nop 0
    buffer_load_dwordx4 v6, s[64:67], s74 offen lds
    s_add_u32 s74, s74, 16384
    s_waitcnt vmcnt(5)
    ds_read_b64_tr_b16 v[108:109], v8 offset:0
    ds_read_b64_tr_b16 v[110:111], v8 offset:512
    s_waitcnt lgkmcnt(0)
    s_add_u32 s77, s76, 0
    s_mov_b32 m0, s77
    s_nop 0
    buffer_load_dwordx4 v6, s[64:67], s74 offen lds
    s_add_u32 s74, s74, 16384
    s_waitcnt vmcnt(5)
    ds_read_b64_tr_b16 v[112:113], v8 offset:1024
    ds_read_b64_tr_b16 v[114:115], v8 offset:1536
    s_waitcnt lgkmcnt(0)
    s_add_u32 s77, s76, 1024
    s_mov_b32 m0, s77
    s_nop 0
    buffer_load_dwordx4 v6, s[64:67], s74 offen lds
    s_add_u32 s74, s74, 16384
    s_waitcnt vmcnt(5)
    ds_read_b64_tr_b16 v[116:117], v8 offset:2048
    ds_read_b64_tr_b16 v[118:119], v8 offset:2560
    s_waitcnt lgkmcnt(0)
    s_add_u32 s77, s76, 2048
    s_mov_b32 m0, s77
    s_nop 0
    buffer_load_dwordx4 v6, s[64:67], s74 offen lds
    s_add_u32 s74, s74, 16384
    s_waitcnt vmcnt(5)
    ds_read_b64_tr_b16 v[120:121], v8 offset:3072
    ds_read_b64_tr_b16 v[122:123], v8 offset:3584
    s_waitcnt lgkmcnt(0)
    s_add_u32 s77, s76, 3072
    s_mov_b32 m0, s77
    s_nop 0
    buffer_load_dwordx4 v6, s[64:67], s74 offen lds
    s_add_u32 s74, s74, 16384
    s_waitcnt vmcnt(5)
    ds_read_b64_tr_b16 v[124:125], v8 offset:4096
    ds_read_b64_tr_b16 v[126:127], v8 offset:4608
    s_waitcnt lgkmcnt(0)
    s_add_u32 s77, s76, 4096
    s_mov_b32 m0, s77
    s_nop 0
    buffer_load_dwordx4 v6, s[64:67], s74 offen lds
    s_add_u32 s74, s74, 16384
    s_waitcnt vmcnt(5)
    ds_read_b64_tr_b16 v[128:129], v8 offset:5120
    ds_read_b64_tr_b16 v[130:131], v8 offset:5632
    s_waitcnt lgkmcnt(0)
    s_add_u32 s77, s76, 5120
    s_mov_b32 m0, s77
    s_nop 0
    buffer_load_dwordx4 v6, s[64:67], s74 offen lds
    s_add_u32 s74, s74, 16384
    s_waitcnt vmcnt(5)
    ds_read_b64_tr_b16 v[132:133], v8 offset:0
    ds_read_b64_tr_b16 v[134:135], v8 offset:512
    s_waitcnt lgkmcnt(0)
    s_add_u32 s77, s76, 0
    s_mov_b32 m0, s77
    s_nop 0
    buffer_load_dwordx4 v6, s[64:67], s74 offen lds
    s_add_u32 s74, s74, 16384
    s_waitcnt vmcnt(5)
    ds_read_b64_tr_b16 v[136:137], v8 offset:1024
    ds_read_b64_tr_b16 v[138:139], v8 offset:1536
    s_waitcnt lgkmcnt(0)
    s_add_u32 s77, s76, 1024
    s_mov_b32 m0, s77
    s_nop 0
    buffer_load_dwordx4 v6, s[64:67], s74 offen lds
    s_add_u32 s74, s74, 16384
    s_waitcnt vmcnt(5)
    ds_read_b64_tr_b16 v[140:141], v8 offset:2048
    ds_read_b64_tr_b16 v[142:143], v8 offset:2560
    s_waitcnt vmcnt(4)
    ds_read_b64_tr_b16 v[144:145], v8 offset:3072
    ds_read_b64_tr_b16 v[146:147], v8 offset:3584
    v_mov_b32 v9, v8
    s_mov_b32 s74, 262144
    v_lshrrev_b32 v6, 3, v1
    v_mul_u32_u24 v6, 4352, v6
    v_and_b32 v7, 7, v1
    v_lshl_add_u32 v6, v7, 4, v6
L_pollA:
    buffer_load_dwordx4 v[12:15], v6, s[48:51], s74 offen sc1
    s_waitcnt vmcnt(0)
    v_xor_b32 v12, s99, v12
    v_xor_b32 v13, s99, v13
    v_xor_b32 v14, s99, v14
    v_xor_b32 v15, s99, v15
    v_or3_b32 v12, v12, v13, v14
    v_or_b32 v12, v12, v15
    v_cmp_ne_u32 vcc, 0, v12
    s_nop 0
    s_cbranch_vccz L_polledA
    s_sleep 8
    s_sub_u32 s83, s83, 16
    s_cbranch_scc0 L_pollA
    s_mov_b32 s83, 0
L_polledA:
    s_or_b32 s74, s2, s68
    s_cmp_lg_u32 s74, 0
    s_cbranch_scc1 L_nogen
    v_mov_b32 v6, 327680
    v_mov_b32 v7, s99
    s_mov_b64 exec, 1
    buffer_store_dword v7, v6, s[48:51], 0 offen sc1
    s_mov_b64 exec, -1
L_nogen:
    s_lshl_b32 s74, s69, 6
    s_and_b32 s75, s70, 1
    s_lshl_b32 s75, s75, 5
    s_add_u32 s74, s74, s75
    v_and_b32 v6, 31, v1
    v_add_u32 v6, s74, v6
    s_lshr_b32 s74, s70, 1
    s_lshl_b32 s74, s74, 7
    s_lshl_b32 s75, s68, 5
    s_add_u32 s74, s74, s75
    v_lshrrev_b32 v7, 5, v1
    v_lshlrev_b32 v7, 2, v7
    v_add_u32 v7, s74, v7
    v_lshlrev_b32 v11, 10, v6
    v_lshl_add_u32 v11, v7, 1, v11
    v_lshrrev_b32 v8, 5, v1
    v_lshl_add_u32 v11, v8, 3, v11
    v_lshlrev_b32 v7, 12, v7
    v_lshl_add_u32 v7, v6, 1, v7
    v_add_u32 v7, 4194304, v7
    v_lshlrev_b32 v6, 2, v6
    s_mov_b32 s74, 131072
    buffer_load_dword v10, v6, s[48:51], s74 offen sc1
L_bpoll:
    s_mov_b32 s74, 0
    buffer_load_ushort v12, v7, s[48:51], s74 offen sc1
    s_mov_b32 s74, 4096
    buffer_load_ushort v13, v7, s[48:51], s74 offen sc1
    s_mov_b32 s74, 8192
    buffer_load_ushort v14, v7, s[48:51], s74 offen sc1
    s_mov_b32 s74, 12288
    buffer_load_ushort v15, v7, s[48:51], s74 offen sc1
    s_mov_b32 s74, 32768
    buffer_load_ushort v16, v7, s[48:51], s74 offen sc1
    s_mov_b32 s74, 36864
    buffer_load_ushort v17, v7, s[48:51], s74 offen sc1
    s_mov_b32 s74, 40960
    buffer_load_ushort v18, v7, s[48:51], s74 offen sc1
    s_mov_b32 s74, 45056
    buffer_load_ushort v19, v7, s[48:51], s74 offen sc1
    s_mov_b32 s74, 65536
    buffer_load_ushort v20, v7, s[48:51], s74 offen sc1
    s_mov_b32 s74, 69632
    buffer_load_ushort v21, v7, s[48:51], s74 offen sc1
    s_mov_b32 s74, 73728
    buffer_load_ushort v22, v7, s[48:51], s74 offen sc1
    s_mov_b32 s74, 77824
    buffer_load_ushort v23, v7, s[48:51], s74 offen sc1
    s_mov_b32 s74, 98304
    buffer_load_ushort v24, v7, s[48:51], s74 offen sc1
    s_mov_b32 s74, 102400
    buffer_load_ushort v25, v7, s[48:51], s74 offen sc1
    s_mov_b32 s74, 106496
    buffer_load_ushort v26, v7, s[48:51], s74 offen sc1
    s_mov_b32 s74, 110592
    buffer_load_ushort v27, v7, s[48:51], s74 offen sc1
    s_waitcnt vmcnt(0)
    v_max3_u32 v8, v12, v13, v14
    v_max3_u32 v8, v8, v15, v16
    v_max3_u32 v8, v8, v17, v18
    v_max3_u32 v8, v8, v19, v20
    v_max3_u32 v8, v8, v21, v22
    v_max3_u32 v8, v8, v23, v24
    v_max3_u32 v8, v8, v25, v26
    v_max_u32 v8, v8, v27
    v_cmp_eq_u32 vcc, 0xffff, v8
    s_nop 0
    s_cbranch_vccz L_bok
    s_sleep 8
    s_sub_u32 s83, s83, 16
    s_cbranch_scc0 L_bpoll
    s_mov_b32 s83, 0
L_bok:
    v_sub_f32 v8, 1.0, v10
    v_lshlrev_b32 v12, 16, v12
    v_mul_f32 v12, v12, v8
    v_lshlrev_b32 v13, 16, v13
    v_mul_f32 v13, v13, v8
    v_lshlrev_b32 v14, 16, v14
    v_mul_f32 v14, v14, v8
    v_lshlrev_b32 v15, 16, v15
    v_mul_f32 v15, v15, v8
    v_lshlrev_b32 v16, 16, v16
    v_mul_f32 v16, v16, v8
    v_lshlrev_b32 v17, 16, v17
    v_mul_f32 v17, v17, v8
    v_lshlrev_b32 v18, 16, v18
    v_mul_f32 v18, v18, v8
    v_lshlrev_b32 v19, 16, v19
    v_mul_f32 v19, v19, v8
    v_lshlrev_b32 v20, 16, v20
    v_mul_f32 v20, v20, v8
    v_lshlrev_b32 v21, 16, v21
    v_mul_f32 v21, v21, v8
    v_lshlrev_b32 v22, 16, v22
    v_mul_f32 v22, v22, v8
    v_lshlrev_b32 v23, 16, v23
    v_mul_f32 v23, v23, v8
    v_lshlrev_b32 v24, 16, v24
    v_mul_f32 v24, v24, v8
    v_lshlrev_b32 v25, 16, v25
    v_mul_f32 v25, v25, v8
    v_lshlrev_b32 v26, 16, v26
    v_mul_f32 v26, v26, v8
    v_lshlrev_b32 v27, 16, v27
    v_mul_f32 v27, v27, v8
L_hfin:
    s_barrier
    s_barrier
    ds_read_b128 v[148:151], v2 offset:0
    ds_read_b128 v[152:155], v2 offset:1024
    ds_read_b128 v[156:159], v2 offset:2048
    ds_read_b128 v[160:163], v2 offset:3072
    s_waitcnt lgkmcnt(3)
    v_mfma_f32_32x32x16_bf16 v[12:27], v[36:39], v[148:151], v[12:27]
    ds_read_b128 v[148:151], v2 offset:4096
    ds_read_b64_tr_b16 v[36:37], v9 offset:4096
    ds_read_b64_tr_b16 v[38:39], v9 offset:4608
    s_waitcnt lgkmcnt(5)
    v_mfma_f32_32x32x16_bf16 v[12:27], v[40:43], v[152:155], v[12:27]
    ds_read_b128 v[152:155], v2 offset:5120
    ds_read_b64_tr_b16 v[40:41], v9 offset:5120
    ds_read_b64_tr_b16 v[42:43], v9 offset:5632
    s_waitcnt lgkmcnt(7)
    v_mfma_f32_32x32x16_bf16 v[12:27], v[44:47], v[156:159], v[12:27]
    ds_read_b128 v[156:159], v2 offset:6144
    ds_read_b64_tr_b16 v[44:45], v9 offset:0
    ds_read_b64_tr_b16 v[46:47], v9 offset:512
    s_waitcnt lgkmcnt(9)
    v_mfma_f32_32x32x16_bf16 v[12:27], v[48:51], v[160:163], v[12:27]
    ds_read_b128 v[160:163], v2 offset:7168
    ds_read_b64_tr_b16 v[48:49], v9 offset:1024
    ds_read_b64_tr_b16 v[50:51], v9 offset:1536
    s_waitcnt lgkmcnt(11)
    v_mfma_f32_32x32x16_bf16 v[12:27], v[52:55], v[148:151], v[12:27]
    ds_read_b128 v[148:151], v2 offset:8192
    s_waitcnt lgkmcnt(9)
    v_mfma_f32_32x32x16_bf16 v[12:27], v[56:59], v[152:155], v[12:27]
    ds_read_b128 v[152:155], v2 offset:9216
    s_waitcnt lgkmcnt(7)
    v_mfma_f32_32x32x16_bf16 v[12:27], v[60:63], v[156:159], v[12:27]
    ds_read_b128 v[156:159], v2 offset:10240
    s_waitcnt lgkmcnt(5)
    v_mfma_f32_32x32x16_bf16 v[12:27], v[64:67], v[160:163], v[12:27]
    ds_read_b128 v[160:163], v2 offset:11264
    s_waitcnt lgkmcnt(3)
    v_mfma_f32_32x32x16_bf16 v[12:27], v[68:71], v[148:151], v[12:27]
    ds_read_b128 v[148:151], v2 offset:12288
    s_waitcnt lgkmcnt(3)
    v_mfma_f32_32x32x16_bf16 v[12:27], v[72:75], v[152:155], v[12:27]
    ds_read_b128 v[152:155], v2 offset:13312
    s_waitcnt lgkmcnt(3)
    v_mfma_f32_32x32x16_bf16 v[12:27], v[76:79], v[156:159], v[12:27]
    ds_read_b128 v[156:159], v2 offset:14336
    s_waitcnt lgkmcnt(3)
    v_mfma_f32_32x32x16_bf16 v[12:27], v[80:83], v[160:163], v[12:27]
    ds_read_b128 v[160:163], v2 offset:15360
    s_waitcnt lgkmcnt(3)
    v_mfma_f32_32x32x16_bf16 v[12:27], v[84:87], v[148:151], v[12:27]
    ds_read_b128 v[148:151], v2 offset:16384
    s_waitcnt lgkmcnt(3)
    v_mfma_f32_32x32x16_bf16 v[12:27], v[88:91], v[152:155], v[12:27]
    ds_read_b128 v[152:155], v2 offset:17408
    s_waitcnt lgkmcnt(3)
    v_mfma_f32_32x32x16_bf16 v[12:27], v[92:95], v[156:159], v[12:27]
    ds_read_b128 v[156:159], v2 offset:18432
    s_waitcnt lgkmcnt(3)
    v_mfma_f32_32x32x16_bf16 v[12:27], v[96:99], v[160:163], v[12:27]
    ds_read_b128 v[160:163], v2 offset:19456
    s_waitcnt lgkmcnt(3)
    v_mfma_f32_32x32x16_bf16 v[12:27], v[100:103], v[148:151], v[12:27]
    ds_read_b128 v[148:151], v2 offset:20480
    s_waitcnt lgkmcnt(3)
    v_mfma_f32_32x32x16_bf16 v[12:27], v[104:107], v[152:155], v[12:27]
    ds_read_b128 v[152:155], v2 offset:21504
    s_waitcnt lgkmcnt(3)
    v_mfma_f32_32x32x16_bf16 v[12:27], v[108:111], v[156:159], v[12:27]
    ds_read_b128 v[156:159], v2 offset:22528
    s_waitcnt lgkmcnt(3)
    v_mfma_f32_32x32x16_bf16 v[12:27], v[112:115], v[160:163], v[12:27]
    ds_read_b128 v[160:163], v2 offset:23552
    s_waitcnt lgkmcnt(3)
    v_mfma_f32_32x32x16_bf16 v[12:27], v[116:119], v[148:151], v[12:27]
    ds_read_b128 v[148:151], v2 offset:24576
    s_waitcnt lgkmcnt(3)
    v_mfma_f32_32x32x16_bf16 v[12:27], v[120:123], v[152:155], v[12:27]
    ds_read_b128 v[152:155], v2 offset:25600
    s_waitcnt lgkmcnt(3)
    v_mfma_f32_32x32x16_bf16 v[12:27], v[124:127], v[156:159], v[12:27]
    ds_read_b128 v[156:159], v2 offset:26624
    s_waitcnt lgkmcnt(3)
    v_mfma_f32_32x32x16_bf16 v[12:27], v[128:131], v[160:163], v[12:27]
    ds_read_b128 v[160:163], v2 offset:27648
    s_waitcnt lgkmcnt(3)
    v_mfma_f32_32x32x16_bf16 v[12:27], v[132:135], v[148:151], v[12:27]
    ds_read_b128 v[148:151], v2 offset:28672
    s_waitcnt lgkmcnt(3)
    v_mfma_f32_32x32x16_bf16 v[12:27], v[136:139], v[152:155], v[12:27]
    ds_read_b128 v[152:155], v2 offset:29696
    s_waitcnt lgkmcnt(3)
    v_mfma_f32_32x32x16_bf16 v[12:27], v[140:143], v[156:159], v[12:27]
    ds_read_b128 v[156:159], v2 offset:30720
    s_waitcnt lgkmcnt(3)
    v_mfma_f32_32x32x16_bf16 v[12:27], v[144:147], v[160:163], v[12:27]
    ds_read_b128 v[160:163], v2 offset:31744
    s_waitcnt lgkmcnt(3)
    v_mfma_f32_32x32x16_bf16 v[12:27], v[36:39], v[148:151], v[12:27]
    s_waitcnt lgkmcnt(2)
    v_mfma_f32_32x32x16_bf16 v[12:27], v[40:43], v[152:155], v[12:27]
    s_waitcnt lgkmcnt(1)
    v_mfma_f32_32x32x16_bf16 v[12:27], v[44:47], v[156:159], v[12:27]
    s_waitcnt lgkmcnt(0)
    v_mfma_f32_32x32x16_bf16 v[12:27], v[48:51], v[160:163], v[12:27]
    s_nop 11
    v_cvt_pk_bf16_f32 v52, v12, v13
    v_cvt_pk_bf16_f32 v53, v14, v15
    v_cvt_pk_bf16_f32 v54, v16, v17
    v_cvt_pk_bf16_f32 v55, v18, v19
    v_cvt_pk_bf16_f32 v56, v20, v21
    v_cvt_pk_bf16_f32 v57, v22, v23
    v_cvt_pk_bf16_f32 v58, v24, v25
    v_cvt_pk_bf16_f32 v59, v26, v27
    v_permlane32_swap_b32 v52, v54
    v_permlane32_swap_b32 v53, v55
    buffer_store_dwordx4 v[52:55], v11, s[52:55], 0 offen offset:0
    v_permlane32_swap_b32 v56, v58
    v_permlane32_swap_b32 v57, v59
    buffer_store_dwordx4 v[56:59], v11, s[52:55], 0 offen offset:32
    s_endpgm
L_main:
    s_sub_u32 s80, s68, 4
    s_lshr_b32 s78, s80, 2
    s_and_b32 s79, s80, 3
    s_lshr_b32 s96, s79, 1
    s_setprio 1
    s_cmp_eq_u32 s78, 0
    s_cbranch_scc1 L_np
    s_setprio 3
L_np:
    v_and_b32 v6, 27, v1
    v_cmp_eq_u32 vcc, 16, v6
    v_mov_b32 v7, 0x3f803f80
    s_nop 0
    v_cndmask_b32 v112, 0, v7, vcc
    v_mov_b32 v113, v112
    v_mov_b32 v114, v112
    v_mov_b32 v115, v112
    v_mov_b32 v116, v112
    v_mov_b32 v117, v112
    v_mov_b32 v118, v112
    v_mov_b32 v119, v112
    v_mov_b32 v120, v112
    v_mov_b32 v121, v112
    v_mov_b32 v122, v112
    v_mov_b32 v123, v112
    v_mov_b32 v124, v112
    v_mov_b32 v125, v112
    v_mov_b32 v126, v112
    v_mov_b32 v127, v112
    v_mov_b32 v128, v112
    v_mov_b32 v129, v112
    v_mov_b32 v130, v112
    v_mov_b32 v131, v112
    v_mov_b32 v132, v112
    v_mov_b32 v133, v112
    v_mov_b32 v134, v112
    v_mov_b32 v135, v112
    v_mov_b32 v136, v112
    v_mov_b32 v137, v112
    v_mov_b32 v138, v112
    v_mov_b32 v139, v112
    v_mov_b32 v140, v112
    v_mov_b32 v141, v112
    v_mov_b32 v142, v112
    v_mov_b32 v143, v112
    v_mov_b32 v80, 0
    v_mov_b32 v81, 0
    v_mov_b32 v82, 0
    v_mov_b32 v83, 0
    v_mov_b32 v84, 0
    v_mov_b32 v85, 0
    v_mov_b32 v86, 0
    v_mov_b32 v87, 0
    v_mov_b32 v88, 0
    v_mov_b32 v89, 0
    v_mov_b32 v90, 0
    v_mov_b32 v91, 0
    v_mov_b32 v92, 0
    v_mov_b32 v93, 0
    v_mov_b32 v94, 0
    v_mov_b32 v95, 0
    v_mov_b32 v76, 0
    v_mov_b32 v77, 0
    v_mov_b32 v78, 0
    v_mov_b32 v79, 0
    s_mov_b32 s89, 0x3fb8aa3b
    s_mov_b32 s90, 0x3e22f983
    v_cmp_lt_u32 s[84:85], 31, v1
    v_mov_b32 v7, 0x41000000
    s_nop 0
    v_cndmask_b32 v22, v7, 1.0, s[84:85]
    v_mov_b32 v7, 0x42800000
    v_mov_b32 v8, 0x43800000
    v_cndmask_b32 v23, v7, v8, s[84:85]
    s_lshl_b32 s74, s80, 12
    s_add_u32 s77, s74, 49152
    v_lshrrev_b32 v6, 5, v1
    v_lshlrev_b32 v6, 11, v6
    v_and_b32 v7, 31, v1
    v_lshl_add_u32 v6, v7, 4, v6
    v_add_u32 v18, s77, v6
    v_xor_b32 v19, 0x80, v18
    v_lshrrev_b32 v6, 2, v1
    v_lshlrev_b32 v6, 4, v6
    v_bfe_u32 v7, v1, 1, 1
    v_mul_u32_u24 v7, 0x280, v7
    v_xor_b32 v6, v6, v7
    v_and_b32 v7, 1, v1
    v_lshl_add_u32 v6, v7, 3, v6
    v_add_u32 v20, s77, v6
    s_waitcnt lgkmcnt(0)
    s_lshl_b32 s74, s96, 4
    s_lshr_b32 s75, s72, s74
    s_lshl_b32 s75, s75, 16
    v_mov_b32 v6, s75
    v_mul_f32 v7, 0x3fb8aa3b, v6
    v_fma_f32 v8, v6, s89, -v7
    v_fmac_f32 v8, 0x32a57060, v6
    v_exp_f32 v21, v7
    v_mul_f32 v8, 0x3f317218, v8
    v_fma_f32 v21, v21, v8, v21
    v_cvt_pk_bf16_f32 v21, v21, v21
    v_lshlrev_b32 v21, 16, v21
    s_waitcnt vmcnt(0)
    v_and_b32 v6, 0x7fff, v16
    v_and_b32 v7, 0x7fff, v17
    v_max_u32 v6, v6, v7
    s_nop 1
    v_max_u32_dpp v6, v6, v6 row_shr:1 row_mask:0xf bank_mask:0xf
    s_nop 1
    v_max_u32_dpp v6, v6, v6 row_shr:2 row_mask:0xf bank_mask:0xf
    s_nop 1
    v_max_u32_dpp v6, v6, v6 row_shr:4 row_mask:0xf bank_mask:0xf
    s_nop 1
    v_max_u32_dpp v6, v6, v6 row_shr:8 row_mask:0xf bank_mask:0xf
    s_nop 0
    v_readlane_b32 s74, v6, 15
    v_readlane_b32 s75, v6, 31
    s_nop 0
    s_max_u32 s74, s74, s75
    s_lshr_b32 s74, s74, 7
    s_max_u32 s74, s74, 1
    s_min_u32 s74, s74, 253
    s_lshl_b32 s91, s74, 23
    s_sub_u32 s74, 254, s74
    s_lshl_b32 s92, s74, 23
    v_lshlrev_b32 v6, 16, v14
    v_mul_f32 v7, 0x3fb8aa3b, v6
    v_fma_f32 v8, v6, s89, -v7
    v_fmac_f32 v8, 0x32a57060, v6
    v_exp_f32 v66, v7
    v_mul_f32 v8, 0x3f317218, v8
    v_fma_f32 v66, v66, v8, v66
    v_cvt_pk_bf16_f32 v66, v66, v66
    v_lshlrev_b32 v66, 16, v66
    v_mul_f32 v66, v66, v21
    v_mul_f32 v66, 0xbfb8aa3b, v66
    v_lshlrev_b32 v6, 16, v15
    v_mul_f32 v6, v6, v21
    v_cndmask_b32 v6, v6, -v6, s[84:85]
    v_mul_f32 v67, 0x3e22f983, v6
    v_fma_f32 v68, v6, s90, -v67
    v_fmac_f32 v68, 0x31dc9c88, v6
    v_mul_f32 v6, v66, v22
    v_mul_f32 v7, v67, v22
    v_exp_f32 v69, v6
    v_fract_f32 v7, v7
    v_fmac_f32 v7, v68, v22
    v_cos_f32 v8, v7
    v_sin_f32 v9, v7
    v_mul_f32 v40, v69, v8
    v_mul_f32 v41, v69, v9
    v_mul_f32 v6, v66, v23
    v_mul_f32 v7, v67, v23
    v_exp_f32 v69, v6
    v_fract_f32 v7, v7
    v_fmac_f32 v7, v68, v23
    v_cos_f32 v8, v7
    v_sin_f32 v9, v7
    v_mul_f32 v42, v69, v8
    v_mul_f32 v43, v69, v9
    v_lshlrev_b32 v6, 16, v16
    v_lshlrev_b32 v7, 16, v17
    v_mul_f32 v6, s92, v6
    v_mul_f32 v7, s92, v7
    v_cndmask_b32 v24, 1.0, v6, s[84:85]
    v_cndmask_b32 v25, 0, -v7, s[84:85]
    v_pk_mul_f32 v[46:47], v[40:41], v[40:41] op_sel:[0,0] op_sel_hi:[0,1]
    v_pk_fma_f32 v[46:47], v[40:41], v[40:41], v[46:47] op_sel:[1,1,0] op_sel_hi:[1,0,1] neg_lo:[1,0,0]
    v_pk_mul_f32 v[26:27], v[24:25], v[40:41] op_sel:[0,0] op_sel_hi:[0,1]
    v_pk_fma_f32 v[26:27], v[24:25], v[40:41], v[26:27] op_sel:[1,1,0] op_sel_hi:[1,0,1] neg_lo:[1,0,0]
    v_pk_mul_f32 v[44:45], v[42:43], v[42:43] op_sel:[0,0] op_sel_hi:[0,1]
    v_pk_fma_f32 v[44:45], v[42:43], v[42:43], v[44:45] op_sel:[1,1,0] op_sel_hi:[1,0,1] neg_lo:[1,0,0]
    v_pk_mul_f32 v[28:29], v[24:25], v[46:47] op_sel:[0,0] op_sel_hi:[0,1]
    v_pk_fma_f32 v[28:29], v[24:25], v[46:47], v[28:29] op_sel:[1,1,0] op_sel_hi:[1,0,1] neg_lo:[1,0,0]
    v_pk_mul_f32 v[30:31], v[26:27], v[46:47] op_sel:[0,0] op_sel_hi:[0,1]
    v_pk_fma_f32 v[30:31], v[26:27], v[46:47], v[30:31] op_sel:[1,1,0] op_sel_hi:[1,0,1] neg_lo:[1,0,0]
    v_pk_mul_f32 v[64:65], v[46:47], v[46:47] op_sel:[0,0] op_sel_hi:[0,1]
    v_pk_fma_f32 v[64:65], v[46:47], v[46:47], v[64:65] op_sel:[1,1,0] op_sel_hi:[1,0,1] neg_lo:[1,0,0]
    v_cndmask_b32 v44, v40, v44, s[84:85]
    v_cndmask_b32 v45, v41, v45, s[84:85]
    v_pk_mul_f32 v[32:33], v[24:25], v[64:65] op_sel:[0,0] op_sel_hi:[0,1]
    v_pk_fma_f32 v[32:33], v[24:25], v[64:65], v[32:33] op_sel:[1,1,0] op_sel_hi:[1,0,1] neg_lo:[1,0,0]
    v_pk_mul_f32 v[34:35], v[26:27], v[64:65] op_sel:[0,0] op_sel_hi:[0,1]
    v_pk_fma_f32 v[34:35], v[26:27], v[64:65], v[34:35] op_sel:[1,1,0] op_sel_hi:[1,0,1] neg_lo:[1,0,0]
    v_pk_mul_f32 v[36:37], v[28:29], v[64:65] op_sel:[0,0] op_sel_hi:[0,1]
    v_pk_fma_f32 v[36:37], v[28:29], v[64:65], v[36:37] op_sel:[1,1,0] op_sel_hi:[1,0,1] neg_lo:[1,0,0]
    v_pk_mul_f32 v[38:39], v[30:31], v[64:65] op_sel:[0,0] op_sel_hi:[0,1]
    v_pk_fma_f32 v[38:39], v[30:31], v[64:65], v[38:39] op_sel:[1,1,0] op_sel_hi:[1,0,1] neg_lo:[1,0,0]
    v_cvt_pk_f16_f32 v48, v24, v26
    v_cvt_pk_f16_f32 v49, v28, v30
    v_cvt_pk_f16_f32 v50, v32, v34
    v_cvt_pk_f16_f32 v51, v36, v38
    ds_write_b128 v18, v[48:51] offset:0
    v_cvt_pk_f16_f32 v52, v25, v27
    v_cvt_pk_f16_f32 v53, v29, v31
    v_cvt_pk_f16_f32 v54, v33, v35
    v_cvt_pk_f16_f32 v55, v37, v39
    ds_write_b128 v18, v[52:55] offset:1024
    v_pk_mul_f32 v[56:57], v[24:25], v[42:43] op_sel:[0,0] op_sel_hi:[0,1]
    v_pk_mul_f32 v[58:59], v[26:27], v[42:43] op_sel:[0,0] op_sel_hi:[0,1]
    v_pk_fma_f32 v[24:25], v[24:25], v[42:43], v[56:57] op_sel:[1,1,0] op_sel_hi:[1,0,1] neg_lo:[1,0,0]
    v_pk_mul_f32 v[60:61], v[28:29], v[42:43] op_sel:[0,0] op_sel_hi:[0,1]
    v_pk_fma_f32 v[26:27], v[26:27], v[42:43], v[58:59] op_sel:[1,1,0] op_sel_hi:[1,0,1] neg_lo:[1,0,0]
    v_pk_mul_f32 v[62:63], v[30:31], v[42:43] op_sel:[0,0] op_sel_hi:[0,1]
    v_pk_fma_f32 v[28:29], v[28:29], v[42:43], v[60:61] op_sel:[1,1,0] op_sel_hi:[1,0,1] neg_lo:[1,0,0]
    v_pk_mul_f32 v[56:57], v[32:33], v[42:43] op_sel:[0,0] op_sel_hi:[0,1]
    v_pk_fma_f32 v[30:31], v[30:31], v[42:43], v[62:63] op_sel:[1,1,0] op_sel_hi:[1,0,1] neg_lo:[1,0,0]
    v_pk_mul_f32 v[58:59], v[34:35], v[42:43] op_sel:[0,0] op_sel_hi:[0,1]
    v_pk_fma_f32 v[32:33], v[32:33], v[42:43], v[56:57] op_sel:[1,1,0] op_sel_hi:[1,0,1] neg_lo:[1,0,0]
    v_pk_mul_f32 v[60:61], v[36:37], v[42:43] op_sel:[0,0] op_sel_hi:[0,1]
    v_pk_fma_f32 v[34:35], v[34:35], v[42:43], v[58:59] op_sel:[1,1,0] op_sel_hi:[1,0,1] neg_lo:[1,0,0]
    v_pk_mul_f32 v[62:63], v[38:39], v[42:43] op_sel:[0,0] op_sel_hi:[0,1]
    v_pk_fma_f32 v[36:37], v[36:37], v[42:43], v[60:61] op_sel:[1,1,0] op_sel_hi:[1,0,1] neg_lo:[1,0,0]
    v_pk_fma_f32 v[38:39], v[38:39], v[42:43], v[62:63] op_sel:[1,1,0] op_sel_hi:[1,0,1] neg_lo:[1,0,0]
    v_cvt_pk_f16_f32 v48, v24, v26
    v_cvt_pk_f16_f32 v49, v28, v30
    v_cvt_pk_f16_f32 v50, v32, v34
    v_cvt_pk_f16_f32 v51, v36, v38
    ds_write_b128 v19, v[48:51] offset:512
    v_cvt_pk_f16_f32 v52, v25, v27
    v_cvt_pk_f16_f32 v53, v29, v31
    v_cvt_pk_f16_f32 v54, v33, v35
    v_cvt_pk_f16_f32 v55, v37, v39
    ds_write_b128 v19, v[52:55] offset:1536
    ds_read_b64_tr_b16 v[146:147], v20 offset:0
    ds_read_b64_tr_b16 v[148:149], v20 offset:1024
    ds_read_b64_tr_b16 v[150:151], v20 offset:256
    ds_read_b64_tr_b16 v[152:153], v20 offset:1280
    ds_read_b64_tr_b16 v[96:97], v20 offset:2048
    ds_read_b64_tr_b16 v[98:99], v20 offset:3072
    ds_read_b64_tr_b16 v[100:101], v20 offset:2304
    ds_read_b64_tr_b16 v[102:103], v20 offset:3328
    v_pk_mul_f32 v[56:57], v[24:25], v[42:43] op_sel:[0,0] op_sel_hi:[0,1]
    v_pk_mul_f32 v[58:59], v[32:33], v[42:43] op_sel:[0,0] op_sel_hi:[0,1]
    v_pk_fma_f32 v[24:25], v[24:25], v[42:43], v[56:57] op_sel:[1,1,0] op_sel_hi:[1,0,1] neg_lo:[1,0,0]
    v_pk_mul_f32 v[60:61], v[34:35], v[42:43] op_sel:[0,0] op_sel_hi:[0,1]
    v_pk_fma_f32 v[32:33], v[32:33], v[42:43], v[58:59] op_sel:[1,1,0] op_sel_hi:[1,0,1] neg_lo:[1,0,0]
    v_pk_fma_f32 v[34:35], v[34:35], v[42:43], v[60:61] op_sel:[1,1,0] op_sel_hi:[1,0,1] neg_lo:[1,0,0]
    v_pk_mul_f32 v[26:27], v[24:25], v[44:45] op_sel:[0,0] op_sel_hi:[0,1]
    v_pk_fma_f32 v[26:27], v[24:25], v[44:45], v[26:27] op_sel:[1,1,0] op_sel_hi:[1,0,1] neg_lo:[1,0,0]
    v_pk_mul_f32 v[56:57], v[36:37], v[42:43] op_sel:[0,0] op_sel_hi:[0,1]
    v_pk_mul_f32 v[58:59], v[38:39], v[42:43] op_sel:[0,0] op_sel_hi:[0,1]
    v_pk_fma_f32 v[36:37], v[36:37], v[42:43], v[56:57] op_sel:[1,1,0] op_sel_hi:[1,0,1] neg_lo:[1,0,0]
    v_pk_fma_f32 v[38:39], v[38:39], v[42:43], v[58:59] op_sel:[1,1,0] op_sel_hi:[1,0,1] neg_lo:[1,0,0]
    v_pk_mul_f32 v[28:29], v[26:27], v[44:45] op_sel:[0,0] op_sel_hi:[0,1]
    v_pk_fma_f32 v[28:29], v[26:27], v[44:45], v[28:29] op_sel:[1,1,0] op_sel_hi:[1,0,1] neg_lo:[1,0,0]
    v_pk_mul_f32 v[30:31], v[28:29], v[44:45] op_sel:[0,0] op_sel_hi:[0,1]
    v_pk_fma_f32 v[30:31], v[28:29], v[44:45], v[30:31] op_sel:[1,1,0] op_sel_hi:[1,0,1] neg_lo:[1,0,0]
    v_cvt_pk_f16_f32 v48, v24, v26
    v_cvt_pk_f16_f32 v49, v28, v30
    v_cvt_pk_f16_f32 v50, v32, v34
    v_cvt_pk_f16_f32 v51, v36, v38
    ds_write_b128 v18, v[48:51] offset:0
    v_cvt_pk_f16_f32 v52, v25, v27
    v_cvt_pk_f16_f32 v53, v29, v31
    v_cvt_pk_f16_f32 v54, v33, v35
    v_cvt_pk_f16_f32 v55, v37, v39
    ds_write_b128 v18, v[52:55] offset:1024
    v_pk_mul_f32 v[56:57], v[24:25], v[42:43] op_sel:[0,0] op_sel_hi:[0,1]
    v_pk_mul_f32 v[58:59], v[32:33], v[42:43] op_sel:[0,0] op_sel_hi:[0,1]
    v_pk_fma_f32 v[24:25], v[24:25], v[42:43], v[56:57] op_sel:[1,1,0] op_sel_hi:[1,0,1] neg_lo:[1,0,0]
    v_pk_mul_f32 v[60:61], v[34:35], v[42:43] op_sel:[0,0] op_sel_hi:[0,1]
    v_pk_fma_f32 v[32:33], v[32:33], v[42:43], v[58:59] op_sel:[1,1,0] op_sel_hi:[1,0,1] neg_lo:[1,0,0]
    v_pk_fma_f32 v[34:35], v[34:35], v[42:43], v[60:61] op_sel:[1,1,0] op_sel_hi:[1,0,1] neg_lo:[1,0,0]
    v_pk_mul_f32 v[26:27], v[24:25], v[44:45] op_sel:[0,0] op_sel_hi:[0,1]
    v_pk_fma_f32 v[26:27], v[24:25], v[44:45], v[26:27] op_sel:[1,1,0] op_sel_hi:[1,0,1] neg_lo:[1,0,0]
    v_pk_mul_f32 v[56:57], v[36:37], v[42:43] op_sel:[0,0] op_sel_hi:[0,1]
    v_pk_mul_f32 v[58:59], v[38:39], v[42:43] op_sel:[0,0] op_sel_hi:[0,1]
    v_pk_fma_f32 v[36:37], v[36:37], v[42:43], v[56:57] op_sel:[1,1,0] op_sel_hi:[1,0,1] neg_lo:[1,0,0]
    v_pk_fma_f32 v[38:39], v[38:39], v[42:43], v[58:59] op_sel:[1,1,0] op_sel_hi:[1,0,1] neg_lo:[1,0,0]
    v_pk_mul_f32 v[28:29], v[26:27], v[44:45] op_sel:[0,0] op_sel_hi:[0,1]
    v_pk_fma_f32 v[28:29], v[26:27], v[44:45], v[28:29] op_sel:[1,1,0] op_sel_hi:[1,0,1] neg_lo:[1,0,0]
    v_pk_mul_f32 v[30:31], v[28:29], v[44:45] op_sel:[0,0] op_sel_hi:[0,1]
    v_pk_fma_f32 v[30:31], v[28:29], v[44:45], v[30:31] op_sel:[1,1,0] op_sel_hi:[1,0,1] neg_lo:[1,0,0]
    v_cvt_pk_f16_f32 v48, v24, v26
    v_cvt_pk_f16_f32 v49, v28, v30
    v_cvt_pk_f16_f32 v50, v32, v34
    v_cvt_pk_f16_f32 v51, v36, v38
    ds_write_b128 v19, v[48:51] offset:512
    v_cvt_pk_f16_f32 v52, v25, v27
    v_cvt_pk_f16_f32 v53, v29, v31
    v_cvt_pk_f16_f32 v54, v33, v35
    v_cvt_pk_f16_f32 v55, v37, v39
    ds_write_b128 v19, v[52:55] offset:1536
    ds_read_b64_tr_b16 v[154:155], v20 offset:0
    ds_read_b64_tr_b16 v[156:157], v20 offset:1024
    ds_read_b64_tr_b16 v[158:159], v20 offset:256
    ds_read_b64_tr_b16 v[160:161], v20 offset:1280
    ds_read_b64_tr_b16 v[104:105], v20 offset:2048
    ds_read_b64_tr_b16 v[106:107], v20 offset:3072
    ds_read_b64_tr_b16 v[108:109], v20 offset:2304
    ds_read_b64_tr_b16 v[110:111], v20 offset:3328
    v_add_f32 v21, v21, v21
    v_mul_f32 v21, s91, v21
    s_lshl_b32 s74, s79, 2
    v_add_u32 v9, s74, v3
    s_mul_i32 s74, s79, 2592
    s_add_u32 s74, s74, 147728
    v_and_b32 v6, 1, v5
    v_lshrrev_b32 v8, 1, v5
    v_lshlrev_b32 v40, 5, v4
    v_lshl_add_u32 v40, v6, 4, v40
    v_lshrrev_b32 v41, 1, v40
    v_add_u32 v41, 1024, v41
    v_cndmask_b32 v40, v40, v41, s[84:85]
    v_add_u32 v40, s74, v40
    v_lshlrev_b32 v41, 3, v4
    v_lshl_add_u32 v41, v6, 2, v41
    v_lshl_add_u32 v41, v8, 8, v41
    v_add_u32 v41, s74, v41
    v_lshlrev_b32 v42, 2, v4
    v_lshl_add_u32 v42, v8, 7, v42
    v_add_u32 v42, s74, v42
    v_subrev_u32 v8, 4, v42
    v_mov_b32 v6, 0
    s_mov_b64 exec, 1
    ds_add_u32 v3, v166 offset:20
    s_mov_b64 exec, -1
    s_waitcnt lgkmcnt(1)
    v_mfma_f32_16x16x32_f16 v[24:27], v[96:99], v[146:149], 0
    v_mfma_f32_16x16x32_f16 v[28:31], v[96:99], v[154:157], 0
    v_mfma_f32_16x16x32_f16 v[32:35], v[104:107], v[146:149], 0
    v_mfma_f32_16x16x32_f16 v[36:39], v[104:107], v[154:157], 0
    v_mfma_f32_16x16x32_f16 v[24:27], v[100:103], v[150:153], v[24:27]
    v_mfma_f32_16x16x32_f16 v[28:31], v[100:103], v[158:161], v[28:31]
    v_mfma_f32_16x16x32_f16 v[32:35], v[108:111], v[150:153], v[32:35]
    v_mfma_f32_16x16x32_f16 v[36:39], v[108:111], v[158:161], v[36:39]
    s_nop 4
    v_mul_f32 v24, v24, v21
    v_mul_f32 v25, v25, v21
    v_mul_f32 v26, v26, v21
    v_mul_f32 v27, v27, v21
    v_mul_f32 v28, v28, v21
    v_mul_f32 v29, v29, v21
    v_mul_f32 v30, v30, v21
    v_mul_f32 v31, v31, v21
    v_mul_f32 v32, v32, v21
    v_mul_f32 v33, v33, v21
    v_mul_f32 v34, v34, v21
    v_mul_f32 v35, v35, v21
    v_mul_f32 v36, v36, v21
    v_mul_f32 v37, v37, v21
    v_mul_f32 v38, v38, v21
    s_cmp_eq_u32 s78, 1
    s_cbranch_scc1 L_kgw
L_wt18:
    ds_read_b32 v165, v9 offset:72
    s_waitcnt lgkmcnt(0)
    v_readfirstlane_b32 s93, v165
    s_nop 0
    s_cmp_ge_u32 s93, 1
    s_cbranch_scc1 L_wd18
    s_sleep 1
    s_sub_u32 s83, s83, 1
    s_cbranch_scc0 L_wt18
    s_mov_b32 s83, 0
L_wd18:
    s_mov_b32 exec_hi, 0
    ds_read_b128 v[96:99], v40
    ds_read_b128 v[100:103], v40 offset:512
    s_mov_b64 exec, s[84:85]
    ds_read_b32 v96, v40
    ds_read_b32 v98, v40 offset:4
    ds_read_b32 v100, v40 offset:256
    ds_read_b32 v102, v40 offset:260
    s_mov_b64 exec, -1
    ds_read_b32 v104, v41 offset:1536
    ds_read_b32 v108, v41 offset:1664
    ds_read_b32 v105, v42 offset:2048
    ds_read_b32 v109, v42 offset:2112
    ds_read_b32 v106, v42 offset:2304
    ds_read_b32 v110, v42 offset:2368
    ds_read_b32 v107, v42 offset:2560
    s_waitcnt lgkmcnt(0)
    v_add_f32 v24, v24, v96
    v_add_f32 v25, v25, v97
    v_add_f32 v26, v26, v98
    v_add_f32 v27, v27, v99
    v_add_f32 v28, v28, v100
    v_add_f32 v29, v29, v101
    v_add_f32 v30, v30, v102
    v_add_f32 v31, v31, v103
    v_add_f32 v32, v32, v104
    v_add_f32 v33, v33, v105
    v_add_f32 v34, v34, v106
    v_add_f32 v35, v35, v107
    v_add_f32 v36, v36, v108
    v_add_f32 v37, v37, v109
    v_add_f32 v38, v38, v110
L_kgw:
    ds_write_b32 v41, v32 offset:1536
    ds_write_b32 v41, v36 offset:1664
    s_mov_b32 exec_hi, 0
    ds_write_b128 v40, v[24:27]
    ds_write_b128 v40, v[28:31] offset:512
    s_mov_b64 exec, s[84:85]
    ds_write2_b32 v40, v24, v26 offset0:0 offset1:1
    ds_write2_b32 v40, v28, v30 offset0:64 offset1:65
    s_mov_b32 exec_lo, 0xffff
    s_mov_b32 exec_hi, 0xffff
    ds_write_b32 v42, v33 offset:2048
    ds_write_b32 v42, v37 offset:2112
    ds_write_b32 v42, v34 offset:2304
    ds_write_b32 v42, v38 offset:2368
    s_mov_b64 exec, 1
    ds_write_b32 v42, v35 offset:2560
    ds_write_b32 v8, v6
    ds_add_u32 v9, v166 offset:72
    s_mov_b64 exec, -1
L_q:
    s_mul_i32 s74, s78, -32768
    s_add_u32 s74, s74, 49152
    v_lshlrev_b32 v6, 10, v4
    v_xor_b32 v7, v5, v4
    v_lshl_add_u32 v6, v7, 4, v6
    v_add_u32 v146, s74, v6
    v_xor_b32 v147, 64, v146
    v_xor_b32 v148, 0x80, v146
    v_xor_b32 v149, 0xc0, v146
    v_bfe_u32 v6, v1, 2, 2
    v_lshrrev_b32 v7, 1, v6
    v_and_b32 v8, 1, v5
    v_lshl_add_u32 v7, v8, 1, v7
    v_xor_b32 v7, s79, v7
    v_lshl_add_u32 v6, v5, 3, v6
    v_lshlrev_b32 v6, 7, v6
    v_lshl_add_u32 v6, v7, 5, v6
    v_and_b32 v7, 3, v1
    v_lshl_add_u32 v6, v7, 3, v6
    v_add_u32 v150, 81920, v6
    s_xor_b32 s74, s78, 1
    s_mul_i32 s74, s74, 148
    v_add_u32 v9, s74, v3
    s_cmp_eq_u32 s78, 1
    s_cbranch_scc1 L_qh
L_wt19:
    ds_read_b32 v165, v3 offset:24
    s_waitcnt lgkmcnt(0)
    v_readfirstlane_b32 s93, v165
    s_nop 0
    s_cmp_ge_u32 s93, 1
    s_cbranch_scc1 L_wd19
    s_sleep 1
    s_sub_u32 s83, s83, 1
    s_cbranch_scc0 L_wt19
    s_mov_b32 s83, 0
L_wd19:
L_wt20:
    ds_read_b32 v165, v3 offset:12
    s_waitcnt lgkmcnt(0)
    v_readfirstlane_b32 s93, v165
    s_nop 0
    s_cmp_ge_u32 s93, 6
    s_cbranch_scc1 L_wd20
    s_sleep 1
    s_sub_u32 s83, s83, 1
    s_cbranch_scc0 L_wt20
    s_mov_b32 s83, 0
L_wd20:
    s_setprio 3
L_qh:
L_wt21:
    ds_read_b32 v165, v3 offset:4
    s_waitcnt lgkmcnt(0)
    v_readfirstlane_b32 s93, v165
    s_nop 0
    s_cmp_ge_u32 s93, 3
    s_cbranch_scc1 L_wd21
    s_sleep 1
    s_sub_u32 s83, s83, 1
    s_cbranch_scc0 L_wt21
    s_mov_b32 s83, 0
L_wd21:
    ds_read_b64_tr_b16 v[48:49], v150 offset:0
    ds_read_b64_tr_b16 v[50:51], v150 offset:512
    ds_read_b128 v[16:19], v146 offset:0
    ds_read_b128 v[20:23], v146 offset:16384
    ds_read_b64_tr_b16 v[52:53], v150 offset:4096
    ds_read_b64_tr_b16 v[54:55], v150 offset:4608
    ds_read_b128 v[24:27], v147 offset:0
    ds_read_b128 v[28:31], v147 offset:16384
    ds_read_b64_tr_b16 v[56:57], v150 offset:8192
    ds_read_b64_tr_b16 v[58:59], v150 offset:8704
    ds_read_b128 v[32:35], v148 offset:0
    ds_read_b128 v[36:39], v148 offset:16384
    ds_read_b64_tr_b16 v[60:61], v150 offset:12288
    ds_read_b64_tr_b16 v[62:63], v150 offset:12800
    ds_read_b128 v[40:43], v149 offset:0
    ds_read_b128 v[44:47], v149 offset:16384
    s_waitcnt lgkmcnt(12)
    v_mfma_f32_16x16x32_bf16 v[152:155], v[48:51], v[16:19], 0
    v_mfma_f32_16x16x32_bf16 v[156:159], v[48:51], v[20:23], 0
    ds_read_b64_tr_b16 v[48:49], v150 offset:16384
    ds_read_b64_tr_b16 v[50:51], v150 offset:16896
    ds_read_b128 v[16:19], v146 offset:256
    ds_read_b128 v[20:23], v146 offset:16640
    s_waitcnt lgkmcnt(12)
    v_mfma_f32_16x16x32_bf16 v[152:155], v[52:55], v[24:27], v[152:155]
    v_mfma_f32_16x16x32_bf16 v[156:159], v[52:55], v[28:31], v[156:159]
    ds_read_b64_tr_b16 v[52:53], v150 offset:20480
    ds_read_b64_tr_b16 v[54:55], v150 offset:20992
    ds_read_b128 v[24:27], v147 offset:256
    ds_read_b128 v[28:31], v147 offset:16640
    s_waitcnt lgkmcnt(12)
    v_mfma_f32_16x16x32_bf16 v[152:155], v[56:59], v[32:35], v[152:155]
    v_mfma_f32_16x16x32_bf16 v[156:159], v[56:59], v[36:39], v[156:159]
    ds_read_b64_tr_b16 v[56:57], v150 offset:24576
    ds_read_b64_tr_b16 v[58:59], v150 offset:25088
    ds_read_b128 v[32:35], v148 offset:256
    ds_read_b128 v[36:39], v148 offset:16640
    s_waitcnt lgkmcnt(12)
    v_mfma_f32_16x16x32_bf16 v[152:155], v[60:63], v[40:43], v[152:155]
    v_mfma_f32_16x16x32_bf16 v[156:159], v[60:63], v[44:47], v[156:159]
    ds_read_b64_tr_b16 v[60:61], v150 offset:28672
    ds_read_b64_tr_b16 v[62:63], v150 offset:29184
    ds_read_b128 v[40:43], v149 offset:256
    ds_read_b128 v[44:47], v149 offset:16640
    s_waitcnt lgkmcnt(12)
    v_mfma_f32_16x16x32_bf16 v[152:155], v[48:51], v[16:19], v[152:155]
    v_mfma_f32_16x16x32_bf16 v[156:159], v[48:51], v[20:23], v[156:159]
    s_waitcnt lgkmcnt(8)
    v_mfma_f32_16x16x32_bf16 v[152:155], v[52:55], v[24:27], v[152:155]
    v_mfma_f32_16x16x32_bf16 v[156:159], v[52:55], v[28:31], v[156:159]
    s_waitcnt lgkmcnt(4)
    v_mfma_f32_16x16x32_bf16 v[152:155], v[56:59], v[32:35], v[152:155]
    v_mfma_f32_16x16x32_bf16 v[156:159], v[56:59], v[36:39], v[156:159]
    s_waitcnt lgkmcnt(0)
    v_mfma_f32_16x16x32_bf16 v[152:155], v[60:63], v[40:43], v[152:155]
    v_mfma_f32_16x16x32_bf16 v[156:159], v[60:63], v[44:47], v[156:159]
L_wt22:
    ds_read_b32 v165, v3 offset:8
    s_waitcnt lgkmcnt(0)
    v_readfirstlane_b32 s93, v165
    s_nop 0
    s_cmp_ge_u32 s93, 1
    s_cbranch_scc1 L_wd22
    s_sleep 1
    s_sub_u32 s83, s83, 1
    s_cbranch_scc0 L_wt22
    s_mov_b32 s83, 0
L_wd22:
    ds_read_b64_tr_b16 v[48:49], v150 offset:32768
    ds_read_b64_tr_b16 v[50:51], v150 offset:33280
    ds_read_b128 v[16:19], v146 offset:512
    ds_read_b128 v[20:23], v146 offset:16896
    ds_read_b64_tr_b16 v[52:53], v150 offset:36864
    ds_read_b64_tr_b16 v[54:55], v150 offset:37376
    ds_read_b128 v[24:27], v147 offset:512
    ds_read_b128 v[28:31], v147 offset:16896
    ds_read_b64_tr_b16 v[56:57], v150 offset:40960
    ds_read_b64_tr_b16 v[58:59], v150 offset:41472
    ds_read_b128 v[32:35], v148 offset:512
    ds_read_b128 v[36:39], v148 offset:16896
    ds_read_b64_tr_b16 v[60:61], v150 offset:45056
    ds_read_b64_tr_b16 v[62:63], v150 offset:45568
    ds_read_b128 v[40:43], v149 offset:512
    ds_read_b128 v[44:47], v149 offset:16896
    s_waitcnt lgkmcnt(12)
    v_mfma_f32_16x16x32_bf16 v[152:155], v[48:51], v[16:19], v[152:155]
    v_mfma_f32_16x16x32_bf16 v[156:159], v[48:51], v[20:23], v[156:159]
    ds_read_b64_tr_b16 v[48:49], v150 offset:49152
    ds_read_b64_tr_b16 v[50:51], v150 offset:49664
    ds_read_b128 v[16:19], v146 offset:768
    ds_read_b128 v[20:23], v146 offset:17152
    s_waitcnt lgkmcnt(12)
    v_mfma_f32_16x16x32_bf16 v[152:155], v[52:55], v[24:27], v[152:155]
    v_mfma_f32_16x16x32_bf16 v[156:159], v[52:55], v[28:31], v[156:159]
    ds_read_b64_tr_b16 v[52:53], v150 offset:53248
    ds_read_b64_tr_b16 v[54:55], v150 offset:53760
    ds_read_b128 v[24:27], v147 offset:768
    ds_read_b128 v[28:31], v147 offset:17152
    s_waitcnt lgkmcnt(12)
    v_mfma_f32_16x16x32_bf16 v[152:155], v[56:59], v[32:35], v[152:155]
    v_mfma_f32_16x16x32_bf16 v[156:159], v[56:59], v[36:39], v[156:159]
    ds_read_b64_tr_b16 v[56:57], v150 offset:57344
    ds_read_b64_tr_b16 v[58:59], v150 offset:57856
    ds_read_b128 v[32:35], v148 offset:768
    ds_read_b128 v[36:39], v148 offset:17152
    s_waitcnt lgkmcnt(12)
    v_mfma_f32_16x16x32_bf16 v[152:155], v[60:63], v[40:43], v[152:155]
    v_mfma_f32_16x16x32_bf16 v[156:159], v[60:63], v[44:47], v[156:159]
    ds_read_b64_tr_b16 v[60:61], v150 offset:61440
    ds_read_b64_tr_b16 v[62:63], v150 offset:61952
    ds_read_b128 v[40:43], v149 offset:768
    ds_read_b128 v[44:47], v149 offset:17152
    s_waitcnt lgkmcnt(12)
    v_mfma_f32_16x16x32_bf16 v[152:155], v[48:51], v[16:19], v[152:155]
    v_mfma_f32_16x16x32_bf16 v[156:159], v[48:51], v[20:23], v[156:159]
    s_mov_b64 exec, 1
    ds_add_u32 v3, v166 offset:16
    s_mov_b64 exec, -1
    s_mov_b64 exec, 1
    ds_add_u32 v9, v166 offset:12
    s_mov_b64 exec, -1
    s_waitcnt lgkmcnt(10)
    v_mfma_f32_16x16x32_bf16 v[152:155], v[52:55], v[24:27], v[152:155]
    v_mfma_f32_16x16x32_bf16 v[156:159], v[52:55], v[28:31], v[156:159]
    s_waitcnt lgkmcnt(6)
    v_mfma_f32_16x16x32_bf16 v[152:155], v[56:59], v[32:35], v[152:155]
    v_mfma_f32_16x16x32_bf16 v[156:159], v[56:59], v[36:39], v[156:159]
    s_waitcnt lgkmcnt(2)
    v_mfma_f32_16x16x32_bf16 v[152:155], v[60:63], v[40:43], v[152:155]
    v_mfma_f32_16x16x32_bf16 v[156:159], v[60:63], v[44:47], v[156:159]
    s_mov_b32 s74, 0x3eb8aa3b
    s_mov_b32 s82, 0
    s_mov_b32 s84, 0xffff
    s_mov_b32 s85, 0xffff
    s_xor_b32 s78, s78, s98
    s_xor_b32 s78, s78, 1
    s_lshl_b32 s75, s69, 1
    s_add_u32 s75, s75, s78
    s_lshl_b32 s75, s75, 5
    s_lshl_b32 s76, s70, 2
    s_add_u32 s75, s75, s76
    s_add_u32 s75, s75, s79
    s_lshl_b32 s75, s75, 10
    s_add_u32 s88, s75, 1048576
    v_mul_f32 v152, s74, v152
    v_mul_f32 v153, s74, v153
    v_mul_f32 v154, s74, v154
    v_mul_f32 v155, s74, v155
    v_mul_f32 v156, s74, v156
    v_mul_f32 v157, s74, v157
    v_mul_f32 v158, s74, v158
    v_mul_f32 v159, s74, v159
    v_cvt_pk_bf16_f32 v10, v152, v153
    v_cvt_pk_bf16_f32 v11, v154, v155
    v_cvt_pk_bf16_f32 v12, v156, v157
    v_cvt_pk_bf16_f32 v13, v158, v159
    s_nop 0
    v_permlane16_swap_b32 v10, v12
    v_permlane16_swap_b32 v11, v13
L_wt23:
    ds_read_b32 v165, v3 offset:96
    s_waitcnt lgkmcnt(0)
    v_readfirstlane_b32 s93, v165
    s_nop 0
    s_cmp_ge_u32 s93, 1
    s_cbranch_scc1 L_wd23
    s_sleep 1
    s_sub_u32 s83, s83, 1
    s_cbranch_scc0 L_wt23
    s_mov_b32 s83, 0
L_wd23:
    s_setprio 1
    s_cmp_lt_u32 s80, 4
    s_cbranch_scc1 L_pr
    s_setprio 3
L_pr:
    s_mov_b32 s81, 0
    v_mov_b32 v14, v2
    v_add_u32 v144, 100, v3
    ds_read_b128 v[104:107], v14
    ds_read_b128 v[96:99], v14 offset:2048
    ds_read_b128 v[100:103], v14 offset:4096
    s_mov_b64 exec, s[84:85]
    ds_read_b128 v[112:115], v14 offset:1024
    ds_read_b128 v[116:119], v14 offset:1280
    ds_read_b128 v[120:123], v14 offset:3072
    ds_read_b128 v[124:127], v14 offset:3328
    s_mov_b64 exec, -1
    s_cmp_lg_u32 s82, 0
    s_waitcnt lgkmcnt(6)
    s_cbranch_scc1 L_setm
    v_mfma_f32_32x32x16_bf16 v[40:55], v[104:107], v[10:13], 0
    s_nop 11
    v_max3_f32 v15, v40, v41, v42
    v_max3_f32 v15, v15, v43, v44
    v_max3_f32 v15, v15, v45, v46
    v_max3_f32 v15, v15, v47, v48
    v_max3_f32 v15, v15, v49, v50
    v_max3_f32 v15, v15, v51, v52
    v_max3_f32 v15, v15, v53, v54
    v_max_f32 v15, v15, v55
L_setm:
    v_mov_b32 v6, v15
    s_nop 1
    v_permlane32_swap_b32 v6, v15
    v_max_f32 v15, v15, v6
    v_sub_f32 v16, 0, v15
    v_sub_f32 v17, 0, v15
    v_sub_f32 v18, 0, v15
    v_sub_f32 v19, 0, v15
    v_sub_f32 v20, 0, v15
    v_sub_f32 v21, 0, v15
    v_sub_f32 v22, 0, v15
    v_sub_f32 v23, 0, v15
    v_sub_f32 v24, 0, v15
    v_sub_f32 v25, 0, v15
    v_sub_f32 v26, 0, v15
    v_sub_f32 v27, 0, v15
    v_sub_f32 v28, 0, v15
    v_sub_f32 v29, 0, v15
    v_sub_f32 v30, 0, v15
    v_sub_f32 v31, 0, v15
    s_nop 1
    v_mfma_f32_32x32x16_bf16 v[40:55], v[104:107], v[10:13], v[16:31]
    s_nop 9
.p2align 6
L_loop:
    s_waitcnt lgkmcnt(0)
    v_mfma_f32_32x32x16_bf16 v[56:71], v[96:99], v[10:13], v[16:31]
    v_exp_f32 v40, v40
    v_exp_f32 v41, v41
    v_exp_f32 v42, v42
    v_exp_f32 v43, v43
    v_mfma_f32_32x32x16_bf16 v[80:95], v[140:143], v[76:79], v[80:95]
    ds_read_b128 v[104:107], v14 offset:6144
    ds_read_b128 v[108:111], v14 offset:8192
    s_mov_b64 exec, s[84:85]
    ds_read_b128 v[128:131], v14 offset:5120
    ds_read_b128 v[132:135], v14 offset:5376
    ds_read_b128 v[136:139], v14 offset:7168
    ds_read_b128 v[140:143], v14 offset:7424
    s_mov_b64 exec, -1
    ds_read_b32 v145, v144
    v_cvt_pk_bf16_f32 v72, v40, v41
    v_exp_f32 v44, v44
    v_exp_f32 v45, v45
    v_cvt_pk_bf16_f32 v73, v42, v43
    v_exp_f32 v46, v46
    v_exp_f32 v47, v47
    v_cvt_pk_bf16_f32 v74, v44, v45
    v_exp_f32 v48, v48
    v_cvt_pk_bf16_f32 v75, v46, v47
    v_exp_f32 v49, v49
    v_exp_f32 v50, v50
    v_mfma_f32_32x32x16_bf16 v[80:95], v[112:115], v[72:75], v[80:95]
    v_exp_f32 v51, v51
    v_cvt_pk_bf16_f32 v76, v48, v49
    v_exp_f32 v52, v52
    v_exp_f32 v53, v53
    v_cvt_pk_bf16_f32 v77, v50, v51
    v_exp_f32 v54, v54
    v_exp_f32 v55, v55
    v_cvt_pk_bf16_f32 v78, v52, v53
    v_cvt_pk_bf16_f32 v79, v54, v55
    v_mfma_f32_32x32x16_bf16 v[40:55], v[100:103], v[10:13], v[16:31]
    v_exp_f32 v56, v56
    v_exp_f32 v57, v57
    v_exp_f32 v58, v58
    v_exp_f32 v59, v59
    v_mfma_f32_32x32x16_bf16 v[80:95], v[116:119], v[76:79], v[80:95]
    v_cvt_pk_bf16_f32 v72, v56, v57
    v_exp_f32 v60, v60
    v_exp_f32 v61, v61
    v_cvt_pk_bf16_f32 v73, v58, v59
    v_exp_f32 v62, v62
    v_exp_f32 v63, v63
    v_cvt_pk_bf16_f32 v74, v60, v61
    v_exp_f32 v64, v64
    v_cvt_pk_bf16_f32 v75, v62, v63
    v_exp_f32 v65, v65
    v_exp_f32 v66, v66
    v_mfma_f32_32x32x16_bf16 v[80:95], v[120:123], v[72:75], v[80:95]
    v_exp_f32 v67, v67
    v_cvt_pk_bf16_f32 v76, v64, v65
    v_exp_f32 v68, v68
    v_exp_f32 v69, v69
    v_cvt_pk_bf16_f32 v77, v66, v67
    v_exp_f32 v70, v70
    v_exp_f32 v71, v71
    v_cvt_pk_bf16_f32 v78, v68, v69
    v_cvt_pk_bf16_f32 v79, v70, v71
    s_waitcnt lgkmcnt(0)
    v_mfma_f32_32x32x16_bf16 v[56:71], v[104:107], v[10:13], v[16:31]
    v_exp_f32 v40, v40
    v_exp_f32 v41, v41
    v_exp_f32 v42, v42
    v_exp_f32 v43, v43
    v_mfma_f32_32x32x16_bf16 v[80:95], v[124:127], v[76:79], v[80:95]
    ds_read_b128 v[96:99], v14 offset:10240
    ds_read_b128 v[100:103], v14 offset:12288
    s_mov_b64 exec, s[84:85]
    ds_read_b128 v[112:115], v14 offset:9216
    ds_read_b128 v[116:119], v14 offset:9472
    ds_read_b128 v[120:123], v14 offset:11264
    ds_read_b128 v[124:127], v14 offset:11520
    s_mov_b64 exec, -1
    v_cvt_pk_bf16_f32 v72, v40, v41
    v_exp_f32 v44, v44
    v_exp_f32 v45, v45
    v_cvt_pk_bf16_f32 v73, v42, v43
    v_exp_f32 v46, v46
    v_exp_f32 v47, v47
    v_cvt_pk_bf16_f32 v74, v44, v45
    v_exp_f32 v48, v48
    v_cvt_pk_bf16_f32 v75, v46, v47
    v_exp_f32 v49, v49
    v_exp_f32 v50, v50
    v_mfma_f32_32x32x16_bf16 v[80:95], v[128:131], v[72:75], v[80:95]
    v_exp_f32 v51, v51
    v_cvt_pk_bf16_f32 v76, v48, v49
    v_exp_f32 v52, v52
    v_exp_f32 v53, v53
    v_cvt_pk_bf16_f32 v77, v50, v51
    v_exp_f32 v54, v54
    v_exp_f32 v55, v55
    v_cvt_pk_bf16_f32 v78, v52, v53
    v_cvt_pk_bf16_f32 v79, v54, v55
    v_mfma_f32_32x32x16_bf16 v[40:55], v[108:111], v[10:13], v[16:31]
    v_exp_f32 v56, v56
    v_exp_f32 v57, v57
    v_exp_f32 v58, v58
    v_exp_f32 v59, v59
    v_mfma_f32_32x32x16_bf16 v[80:95], v[132:135], v[76:79], v[80:95]
    v_readfirstlane_b32 s93, v145
    v_cvt_pk_bf16_f32 v72, v56, v57
    v_exp_f32 v60, v60
    v_exp_f32 v61, v61
    v_cvt_pk_bf16_f32 v73, v58, v59
    v_exp_f32 v62, v62
    v_exp_f32 v63, v63
    v_cvt_pk_bf16_f32 v74, v60, v61
    v_exp_f32 v64, v64
    v_cvt_pk_bf16_f32 v75, v62, v63
    v_exp_f32 v65, v65
    v_exp_f32 v66, v66
    v_mfma_f32_32x32x16_bf16 v[80:95], v[136:139], v[72:75], v[80:95]
    v_exp_f32 v67, v67
    v_cvt_pk_bf16_f32 v76, v64, v65
    v_exp_f32 v68, v68
    v_exp_f32 v69, v69
    v_cvt_pk_bf16_f32 v77, v66, v67
    v_exp_f32 v70, v70
    v_exp_f32 v71, v71
    v_cvt_pk_bf16_f32 v78, v68, v69
    v_cvt_pk_bf16_f32 v79, v70, v71
    s_waitcnt lgkmcnt(0)
    v_mfma_f32_32x32x16_bf16 v[56:71], v[96:99], v[10:13], v[16:31]
    v_exp_f32 v40, v40
    v_exp_f32 v41, v41
    v_exp_f32 v42, v42
    v_exp_f32 v43, v43
    v_mfma_f32_32x32x16_bf16 v[80:95], v[140:143], v[76:79], v[80:95]
    s_cmp_lg_u32 s93, 1
    s_cbranch_scc1 L_chk
L_chk_ret:
    ds_read_b128 v[104:107], v14 offset:14336
    ds_read_b128 v[108:111], v14 offset:16384
    s_mov_b64 exec, s[84:85]
    ds_read_b128 v[128:131], v14 offset:13312
    ds_read_b128 v[132:135], v14 offset:13568
    ds_read_b128 v[136:139], v14 offset:15360
    ds_read_b128 v[140:143], v14 offset:15616
    s_mov_b64 exec, -1
    v_cvt_pk_bf16_f32 v72, v40, v41
    v_exp_f32 v44, v44
    v_exp_f32 v45, v45
    v_cvt_pk_bf16_f32 v73, v42, v43
    v_exp_f32 v46, v46
    v_exp_f32 v47, v47
    v_cvt_pk_bf16_f32 v74, v44, v45
    v_exp_f32 v48, v48
    v_cvt_pk_bf16_f32 v75, v46, v47
    v_exp_f32 v49, v49
    v_exp_f32 v50, v50
    v_mfma_f32_32x32x16_bf16 v[80:95], v[112:115], v[72:75], v[80:95]
    v_exp_f32 v51, v51
    v_cvt_pk_bf16_f32 v76, v48, v49
    v_exp_f32 v52, v52
    v_exp_f32 v53, v53
    v_cvt_pk_bf16_f32 v77, v50, v51
    v_exp_f32 v54, v54
    v_exp_f32 v55, v55
    v_cvt_pk_bf16_f32 v78, v52, v53
    v_cvt_pk_bf16_f32 v79, v54, v55
    v_mfma_f32_32x32x16_bf16 v[40:55], v[100:103], v[10:13], v[16:31]
    v_exp_f32 v56, v56
    v_exp_f32 v57, v57
    v_exp_f32 v58, v58
    v_exp_f32 v59, v59
    v_mfma_f32_32x32x16_bf16 v[80:95], v[116:119], v[76:79], v[80:95]
    v_cvt_pk_bf16_f32 v72, v56, v57
    v_exp_f32 v60, v60
    v_exp_f32 v61, v61
    v_cvt_pk_bf16_f32 v73, v58, v59
    v_exp_f32 v62, v62
    v_exp_f32 v63, v63
    v_cvt_pk_bf16_f32 v74, v60, v61
    v_exp_f32 v64, v64
    v_cvt_pk_bf16_f32 v75, v62, v63
    v_exp_f32 v65, v65
    v_exp_f32 v66, v66
    v_mfma_f32_32x32x16_bf16 v[80:95], v[120:123], v[72:75], v[80:95]
    v_exp_f32 v67, v67
    v_cvt_pk_bf16_f32 v76, v64, v65
    v_exp_f32 v68, v68
    v_exp_f32 v69, v69
    v_cvt_pk_bf16_f32 v77, v66, v67
    v_exp_f32 v70, v70
    v_exp_f32 v71, v71
    v_cvt_pk_bf16_f32 v78, v68, v69
    v_cvt_pk_bf16_f32 v79, v70, v71
    s_waitcnt lgkmcnt(0)
    v_mfma_f32_32x32x16_bf16 v[56:71], v[104:107], v[10:13], v[16:31]
    v_exp_f32 v40, v40
    v_exp_f32 v41, v41
    v_exp_f32 v42, v42
    v_exp_f32 v43, v43
    v_mfma_f32_32x32x16_bf16 v[80:95], v[124:127], v[76:79], v[80:95]
    ds_read_b128 v[96:99], v14 offset:18432
    ds_read_b128 v[100:103], v14 offset:20480
    s_mov_b64 exec, s[84:85]
    ds_read_b128 v[112:115], v14 offset:17408
    ds_read_b128 v[116:119], v14 offset:17664
    ds_read_b128 v[120:123], v14 offset:19456
    ds_read_b128 v[124:127], v14 offset:19712
    s_mov_b64 exec, -1
    v_cvt_pk_bf16_f32 v72, v40, v41
    v_exp_f32 v44, v44
    v_exp_f32 v45, v45
    v_cvt_pk_bf16_f32 v73, v42, v43
    v_exp_f32 v46, v46
    v_exp_f32 v47, v47
    v_cvt_pk_bf16_f32 v74, v44, v45
    v_exp_f32 v48, v48
    v_cvt_pk_bf16_f32 v75, v46, v47
    v_exp_f32 v49, v49
    v_exp_f32 v50, v50
    v_mfma_f32_32x32x16_bf16 v[80:95], v[128:131], v[72:75], v[80:95]
    v_exp_f32 v51, v51
    v_cvt_pk_bf16_f32 v76, v48, v49
    v_exp_f32 v52, v52
    v_exp_f32 v53, v53
    v_cvt_pk_bf16_f32 v77, v50, v51
    v_exp_f32 v54, v54
    v_exp_f32 v55, v55
    v_cvt_pk_bf16_f32 v78, v52, v53
    v_cvt_pk_bf16_f32 v79, v54, v55
    v_mfma_f32_32x32x16_bf16 v[40:55], v[108:111], v[10:13], v[16:31]
    v_exp_f32 v56, v56
    v_exp_f32 v57, v57
    v_exp_f32 v58, v58
    v_exp_f32 v59, v59
    v_mfma_f32_32x32x16_bf16 v[80:95], v[132:135], v[76:79], v[80:95]
    v_cvt_pk_bf16_f32 v72, v56, v57
    v_exp_f32 v60, v60
    v_exp_f32 v61, v61
    v_cvt_pk_bf16_f32 v73, v58, v59
    v_exp_f32 v62, v62
    v_exp_f32 v63, v63
    v_cvt_pk_bf16_f32 v74, v60, v61
    v_exp_f32 v64, v64
    v_cvt_pk_bf16_f32 v75, v62, v63
    v_exp_f32 v65, v65
    v_exp_f32 v66, v66
    v_mfma_f32_32x32x16_bf16 v[80:95], v[136:139], v[72:75], v[80:95]
    v_exp_f32 v67, v67
    v_cvt_pk_bf16_f32 v76, v64, v65
    v_exp_f32 v68, v68
    v_exp_f32 v69, v69
    v_cvt_pk_bf16_f32 v77, v66, v67
    v_exp_f32 v70, v70
    v_exp_f32 v71, v71
    v_cvt_pk_bf16_f32 v78, v68, v69
    v_cvt_pk_bf16_f32 v79, v70, v71
    v_add_u32 v14, 0x4000, v14
    v_add_u32 v144, 4, v144
    s_add_u32 s81, s81, 1
    s_cmp_lt_u32 s81, 8
    s_cbranch_scc1 L_loop
    v_mfma_f32_32x32x16_bf16 v[80:95], v[140:143], v[76:79], v[80:95]
    s_mov_b32 s74, 0x53800000
    s_waitcnt vmcnt(0) lgkmcnt(0)
    s_nop 9
    v_rcp_f32 v40, v88
    v_cmp_nlt_f32 vcc, v88, s74
    v_mul_f32 v40, v40, v146
    v_mul_f32 v80, v80, v40
    v_mul_f32 v81, v81, v40
    v_mul_f32 v82, v82, v40
    v_mul_f32 v83, v83, v40
    v_mul_f32 v84, v84, v40
    v_mul_f32 v85, v85, v40
    v_mul_f32 v86, v86, v40
    v_mul_f32 v87, v87, v40
    v_add_f32 v42, v83, v84
    v_add_f32 v43, v85, v86
    v_add_f32 v42, v42, v87
    v_add_f32 v43, v43, v80
    v_add_f32 v42, v42, v81
    v_add_f32 v43, v43, v82
    v_add_f32 v42, v42, v43
    v_mov_b32 v44, 0x207
    v_cmp_class_f32 s[86:87], v42, v44
    s_nop 0
    s_or_b64 vcc, vcc, s[86:87]
    s_cbranch_vccz L_att_ok
    s_cmp_lg_u32 s82, 0
    s_cbranch_scc1 L_att_ok
    s_mov_b32 s82, 1
    v_mov_b32 v14, v2
    v_mov_b32 v15, 0xff7fffff
    s_mov_b32 s81, 0
L_maxloop:
    ds_read_b128 v[96:99], v14
    v_add_u32 v14, 2048, v14
    s_waitcnt lgkmcnt(0)
    v_mfma_f32_32x32x16_bf16 v[40:55], v[96:99], v[10:13], 0
    s_nop 11
    v_max3_f32 v15, v15, v40, v41
    v_max3_f32 v15, v15, v42, v43
    v_max3_f32 v15, v15, v44, v45
    v_max3_f32 v15, v15, v46, v47
    v_max3_f32 v15, v15, v48, v49
    v_max3_f32 v15, v15, v50, v51
    v_max3_f32 v15, v15, v52, v53
    v_max3_f32 v15, v15, v54, v55
    s_add_u32 s81, s81, 1
    s_cmp_lt_u32 s81, 64
    s_cbranch_scc1 L_maxloop
    v_mov_b32 v80, 0
    v_mov_b32 v81, 0
    v_mov_b32 v82, 0
    v_mov_b32 v83, 0
    v_mov_b32 v84, 0
    v_mov_b32 v85, 0
    v_mov_b32 v86, 0
    v_mov_b32 v87, 0
    v_mov_b32 v88, 0
    v_mov_b32 v89, 0
    v_mov_b32 v90, 0
    v_mov_b32 v91, 0
    v_mov_b32 v92, 0
    v_mov_b32 v93, 0
    v_mov_b32 v94, 0
    v_mov_b32 v95, 0
    v_mov_b32 v76, 0
    v_mov_b32 v77, 0
    v_mov_b32 v78, 0
    v_mov_b32 v79, 0
    s_branch L_pr
L_chk:
L_wt24:
    ds_read_b32 v165, v144 offset:0
    s_waitcnt lgkmcnt(0)
    v_readfirstlane_b32 s93, v165
    s_nop 0
    s_cmp_ge_u32 s93, 1
    s_cbranch_scc1 L_wd24
    s_sleep 1
    s_sub_u32 s83, s83, 1
    s_cbranch_scc0 L_wt24
    s_mov_b32 s83, 0
L_wd24:
    s_cmp_lt_u32 s93, 2
    s_cbranch_scc1 L_chk_ret
    s_lshl_b32 s74, s69, 8
    s_lshl_b32 s75, s78, 7
    s_add_u32 s74, s74, s75
    s_add_u32 s74, s74, 131072
    v_and_b32 v6, 31, v1
    v_lshlrev_b32 v6, 2, v6
    buffer_load_dword v146, v6, s[48:51], s74 offen sc1
    ds_read_b32 v147, v3 offset:36
L_wt25:
    ds_read_b32 v165, v3 offset:32
    s_waitcnt lgkmcnt(0)
    v_readfirstlane_b32 s93, v165
    s_nop 0
    s_cmp_ge_u32 s93, 1
    s_cbranch_scc1 L_wd25
    s_sleep 4
    s_sub_u32 s83, s83, 1
    s_cbranch_scc0 L_wt25
    s_mov_b32 s83, 0
L_wd25:
    v_readfirstlane_b32 s91, v147
    s_setprio 0
    s_branch L_chk_ret
L_att_ok:
    s_mov_b32 s74, 0xfffffffe
    v_cvt_pk_bf16_f32 v72, v80, v81
    v_min_u32 v72, s74, v72
    v_cvt_pk_bf16_f32 v73, v82, v83
    v_min_u32 v73, s74, v73
    v_cvt_pk_bf16_f32 v74, v84, v85
    v_min_u32 v74, s74, v74
    v_cvt_pk_bf16_f32 v75, v86, v87
    v_min_u32 v75, s74, v75
    s_cmp_eq_u32 s91, 1
    s_cbranch_scc1 L_oloc
    buffer_store_dwordx4 v[72:75], v2, s[48:51], s88 offen sc1
    s_branch L_ost
L_oloc:
    buffer_store_dwordx4 v[72:75], v2, s[48:51], s88 offen
L_ost:
    s_lshl_b32 s74, s69, 1
    s_and_b32 s75, s70, 1
    s_add_u32 s74, s74, s75
    s_lshl_b32 s74, s74, 15
    s_lshl_b32 s75, s80, 12
    s_add_u32 s74, s74, s75
    s_add_u32 s74, s74, 1048576
    v_add_u32 v6, s75, v2
    s_lshl_b32 s75, s80, 2
    v_add_u32 v7, s75, v3
    s_barrier
L_opoll:
    buffer_load_dwordx4 v[40:43], v2, s[48:51], s74 offen offset:0 sc1
    buffer_load_dwordx4 v[44:47], v2, s[48:51], s74 offen offset:1024 sc1
    buffer_load_dwordx4 v[48:51], v2, s[48:51], s74 offen offset:2048 sc1
    buffer_load_dwordx4 v[52:55], v2, s[48:51], s74 offen offset:3072 sc1
    s_waitcnt vmcnt(0)
    v_max3_u32 v8, v40, v41, v42
    v_max3_u32 v8, v8, v43, v44
    v_max3_u32 v8, v8, v45, v46
    v_max3_u32 v8, v8, v47, v48
    v_max3_u32 v8, v8, v49, v50
    v_max3_u32 v8, v8, v51, v52
    v_max3_u32 v8, v8, v53, v54
    v_max_u32 v8, v8, v55
    v_cmp_eq_u32 vcc, -1, v8
    s_nop 0
    s_cbranch_vccz L_ook
    s_sub_u32 s83, s83, 16
    s_cbranch_scc0 L_opoll
    s_mov_b32 s83, 0
L_ook:
    ds_write_b128 v6, v[40:43] offset:0
    ds_write_b128 v6, v[44:47] offset:1024
    ds_write_b128 v6, v[48:51] offset:2048
    ds_write_b128 v6, v[52:55] offset:3072
    s_waitcnt lgkmcnt(0)
    s_barrier
    s_endpgm
L_end:
    s_endpgm

.section .rodata,"a"
.p2align 6
.amdhsa_kernel gated_mix__grouped_kv_mqa__ssm_conv_s4d__prompt_kernel
  .amdhsa_next_free_vgpr 168
  .amdhsa_next_free_sgpr 102
  .amdhsa_accum_offset 168
  .amdhsa_group_segment_fixed_size 0
  .amdhsa_kernarg_size 128
  .amdhsa_user_sgpr_count 2
  .amdhsa_user_sgpr_kernarg_segment_ptr 1
  .amdhsa_system_sgpr_workgroup_id_x 1
.end_amdhsa_kernel
```
